```python
import torch

def _softmax(x, axis=-1):
    return torch.softmax(x, dim=axis)
def _gelu(x):
    return torch.nn.functional.gelu(x, approximate="tanh")
def _silu(x):
    return torch.nn.functional.silu(x)
def _sigmoid(x):
    return torch.sigmoid(x)
def _layernorm(x, axis=-1, eps=1e-5):
    m = x.mean(dim=axis, keepdim=True)
    v = x.var(dim=axis, keepdim=True, unbiased=False)
    return (x - m) / torch.sqrt(v + eps)
def _scatter_add(tgt, idx, src, axis=0):
    return tgt.clone().index_add_(axis, idx, src)
def _segment_sum(src, seg, n):
    out = torch.zeros((n,) + src.shape[1:], dtype=src.dtype)
    return out.index_add_(0, seg, src)
def _pad(x, pw):
    flat = tuple(v for pair in reversed(pw) for v in pair)
    return torch.nn.functional.pad(x, flat)

kernel_name = 'concat_heads__sliding_local_dilated__spectral_fnet__prompt'

def setup_inputs():

    _w = (lambda a: (lambda t: t.to(torch.bfloat16) if t.is_floating_point() else t)(torch.as_tensor(a)))
    def _A_setup():
        B, S, D = 1, 2048, 640
        return {
            "x": _w((lambda *s: torch.randn(*s, dtype=torch.bfloat16) * 0.2)(B, S, D)),
            "wqkv": _w((lambda *s: torch.randn(*s, dtype=torch.bfloat16) * 0.8)(D, 3 * D)),
            "wo": _w((lambda *s: torch.randn(*s, dtype=torch.bfloat16) * 0.2)(D, D)),
        }
    _A_in = _A_setup()

    def _B_setup():
        B, S, D = 1, 2048, 640
        ns = torch.arange(S)[:, None] * torch.arange(S)[None, :]
        nd = torch.arange(D)[:, None] * torch.arange(D)[None, :]
        Ws_re = torch.cos(-2.0 * torch.pi * ns / S).to(float)
        Ws_im = torch.sin(-2.0 * torch.pi * ns / S).to(float)
        Wd_re = torch.cos(-2.0 * torch.pi * nd / D).to(float)
        Wd_im = torch.sin(-2.0 * torch.pi * nd / D).to(float)
        return {
            "x": _w((lambda *s: torch.randn(*s, dtype=torch.bfloat16) * 0.05)(B, S, D)),
            "dft_seq_re": _w(Ws_re),
            "dft_seq_im": _w(Ws_im),
            "dft_hid_re": _w(Wd_re),
            "dft_hid_im": _w(Wd_im),
        }
    _B_in = _B_setup()

    return {
        "A_x": _A_in["x"],
        "A_wqkv": _A_in["wqkv"],
        "A_wo": _A_in["wo"],
        "B_x": _B_in["x"],
        "B_dft_seq_re": _B_in["dft_seq_re"],
        "B_dft_seq_im": _B_in["dft_seq_im"],
        "B_dft_hid_re": _B_in["dft_hid_re"],
        "B_dft_hid_im": _B_in["dft_hid_im"],
    }

def reference(A_x, A_wqkv, A_wo, B_x, B_dft_seq_re, B_dft_seq_im, B_dft_hid_re, B_dft_hid_im):
    def _A_ref(x, wqkv, wo):
        B, S, D = x.shape
        H = 32; Dh = D // H
        W, dil = 8, 2
        qkv = (lambda x, *d: x.permute(*d))((x @ wqkv).reshape(B, S, 3, H, Dh), 2, 0, 3, 1, 4)
        q, k, v = qkv[0], qkv[1], qkv[2]
        scale = Dh ** -0.5
        pos = torch.arange(S)
        off = torch.arange(W) * dil
        idx = pos[:, None] - off[None, :]
        mask = idx >= 0
        idx_c = torch.where(mask, idx, 0).reshape(-1)
        kg = k[:, :, idx_c, :].reshape(B, H, S, W, Dh)
        vg = v[:, :, idx_c, :].reshape(B, H, S, W, Dh)
        logits = torch.einsum("bhsd,bhswd->bhsw", q, kg) * scale
        logits = torch.where(mask[None, None, :, :], logits, -1e9)
        attn = _softmax(logits, axis=-1)
        o = torch.einsum("bhsw,bhswd->bhsd", attn, vg)
        return (lambda x, *d: x.permute(*d))(o, 0, 2, 1, 3).reshape(B, S, D) @ wo

    def _B_ref(x, dft_seq_re, dft_seq_im, dft_hid_re, dft_hid_im):
        a = torch.einsum("bsd,ed->bse", x, dft_hid_re)
        b = torch.einsum("bsd,ed->bse", x, dft_hid_im)
        y = torch.einsum("ts,bse->bte", dft_seq_re, a) - torch.einsum("ts,bse->bte", dft_seq_im, b)
        return y

    a = _A_ref(A_x, A_wqkv, A_wo)
    b = _B_ref(B_x, B_dft_seq_re, B_dft_seq_im, B_dft_hid_re, B_dft_hid_im)
    return torch.concatenate([a, b], axis=-1)
```

```asm
; @launch grid=(256,1,1) block=(512,1,1) lds=163840
.amdgcn_target "amdgcn-amd-amdhsa--gfx950"
.text
.globl concat_heads__sliding_local_dilated__spectral_fnet__prompt_kernel
.p2align 8
.type concat_heads__sliding_local_dilated__spectral_fnet__prompt_kernel,@function
concat_heads__sliding_local_dilated__spectral_fnet__prompt_kernel:
    s_lshr_b32 s51, s2, 3
    s_cmp_ge_u32 s51, 32
    s_cbranch_scc1 L_end
    s_load_dwordx8 s[4:11], s[0:1], 0
    v_lshrrev_b32 v1, 6, v0
    v_and_b32 v0, 63, v0
    s_load_dwordx4 s[12:15], s[0:1], 64
    v_readfirstlane_b32 s48, v1
    s_load_dwordx2 s[16:17], s[0:1], 80
    s_cmp_lt_u32 s48, 2
    s_cbranch_scc1 L_e_data
    s_cmp_lg_u32 s48, 2
    s_cbranch_scc1 L_e_done
    s_getpc_b64 s[60:61]
    v_min_u32 v2, 8, v0
    v_mad_u32_u24 v2, s51, 9, v2
    v_lshlrev_b32 v2, 7, v2
    v_min_u32 v2, L_end-concat_heads__sliding_local_dilated__spectral_fnet__prompt_kernel-128, v2
    global_load_dword v47, v2, s[60:61]
    s_branch L_e_done
L_e_data:
    s_cmp_eq_u32 s48, 0
    s_cbranch_scc1 L_e_w
    v_min_u32 v2, 32, v0
    v_mad_u32_u24 v2, s51, 33, v2
    v_and_b32 v3, 1, v2
    v_lshrrev_b32 v2, 1, v2
    v_mad_u32_u24 v2, v2, 20, v3
    s_and_b32 s60, s2, 4
    s_mulk_i32 s60, 2480
    s_and_b32 s61, s2, 2
    s_mulk_i32 s61, 5
    s_add_u32 s60, s60, s61
    v_add_u32 v2, s60, v2
    s_branch L_e_ld
L_e_w:
    v_and_b32 v2, 15, v0
    v_mul_u32_u24 v3, 52, v2
    v_lshrrev_b32 v3, 8, v3
    s_and_b32 s60, s2, 1
    v_add_u32 v3, s60, v3
    v_mad_u32_u24 v2, v3, 5, v2
    v_lshrrev_b32 v3, 4, v0
    v_lshl_add_u32 v3, s51, 2, v3
    v_mad_u32_u24 v2, v3, 30, v2
L_e_ld:
    v_lshlrev_b32 v2, 7, v2
    s_cmp_eq_u32 s48, 0
    s_waitcnt lgkmcnt(0)
    s_cselect_b64 s[60:61], s[6:7], s[4:5]
    global_load_dword v47, v2, s[60:61]
L_e_done:
    s_and_b32 s50, s2, 7
    s_and_b32 s49, s48, 3
    s_cmp_lt_u32 s51, 8
    s_cbranch_scc1 L_B
    s_sub_u32 s70, s51, 8
    s_cmp_ge_u32 s48, 4
    s_cbranch_scc0 L_Acomp
    s_mul_i32 s60, s70, 86
    s_lshr_b32 s60, s60, 8
    s_and_b32 s62, s50, 1
    s_lshl_b32 s62, s62, 3
    s_add_u32 s53, s62, s60
    v_lshrrev_b32 v5, 4, v0
    v_and_b32 v4, 15, v0
    s_lshl_b32 s60, s49, 4
    s_mul_i32 s62, s53, 80
    v_add_u32 v7, s60, v5
    v_mul_u32_u24 v7, 3840, v7
    v_add_u32 v7, s62, v7
    v_lshlrev_b32 v6, 1, v5
    v_sub_u32 v3, v4, v6
    s_lshl_b32 s65, s49, 12
    s_waitcnt lgkmcnt(0)
    s_mov_b32 s24, s6
    s_and_b32 s25, s7, 0xffff
    s_mov_b32 s26, 0x258000
    s_mov_b32 s27, 0x20000
    v_add_u32 v6, 16, v3
    v_and_b32 v6, 15, v6
    v_min_u32 v6, 14, v6
    v_mul_u32_u24 v8, 52, v6
    v_lshrrev_b32 v8, 8, v8
    v_mul_u32_u24 v8, 1200, v8
    v_lshl_add_u32 v6, v6, 4, v8
    v_add_u32 v16, v6, v7
    s_add_u32 m0, s65, 118784
    s_mov_b32 s63, 0
    buffer_load_dwordx4 v16, s[24:27], s63 offen  lds
    v_add_u32 v17, 15360, v16
    s_add_u32 m0, s65, 119808
    s_mov_b32 s63, 0
    buffer_load_dwordx4 v17, s[24:27], s63 offen  lds
    v_add_u32 v6, 8, v3
    v_and_b32 v6, 15, v6
    v_min_u32 v6, 14, v6
    v_mul_u32_u24 v8, 52, v6
    v_lshrrev_b32 v8, 8, v8
    v_mul_u32_u24 v8, 1200, v8
    v_lshl_add_u32 v6, v6, 4, v8
    v_add_u32 v18, v6, v7
    v_add_u32 v18, 30720, v18
    s_add_u32 m0, s65, 120832
    s_mov_b32 s63, 0
    buffer_load_dwordx4 v18, s[24:27], s63 offen  lds
    v_add_u32 v19, 15360, v18
    s_add_u32 m0, s65, 121856
    s_mov_b32 s63, 0
    buffer_load_dwordx4 v19, s[24:27], s63 offen  lds
    s_and_b32 s60, s53, 7
    s_mul_i32 s61, s60, 3
    s_sub_u32 s67, s70, s61
    s_lshr_b32 s62, s50, 2
    s_mul_i32 s62, s62, 3
    s_add_u32 s56, s62, s67
    s_bfe_u32 s54, s2, 0x10001
    s_mul_i32 s60, s56, 352
    s_sub_u32 s60, s60, 32
    s_add_u32 s55, s60, s54
    s_mov_b32 s20, s4
    s_and_b32 s21, s5, 0xffff
    s_mov_b32 s22, 0x280000
    s_mov_b32 s23, 0x20000
    v_lshrrev_b32 v3, 3, v0
    v_and_b32 v4, 7, v0
    v_xor_b32 v4, v4, v5
    s_mul_i32 s60, s49, 48
    v_add_u32 v7, s60, v3
    v_lshl_add_u32 v8, v7, 1, s55
    s_movk_i32 s62, 1280
    v_mul_lo_u32 v8, v8, s62
    v_lshl_add_u32 v1, v4, 4, v8
    v_xor_b32 v2, 64, v1
    v_add_u32 v2, 20480, v2
    v_bfrev_b32 v9, 1
    s_mul_i32 s64, s49, 6144
    v_cmp_gt_u32 vcc, 9, v7
    s_nop 1
    v_cndmask_b32 v10, v1, v9, vcc
    s_add_u32 m0, s64, 135168
    s_movk_i32 s63, 0
    buffer_load_dwordx4 v10, s[20:23], s63 offen  lds
    v_cmp_gt_u32 vcc, 1, v7
    s_nop 1
    v_cndmask_b32 v11, v2, v9, vcc
    s_add_u32 m0, s64, 136192
    s_movk_i32 s63, 0
    buffer_load_dwordx4 v11, s[20:23], s63 offen  lds
    v_add_u32 v12, 40960, v1
    s_add_u32 m0, s64, 137216
    s_movk_i32 s63, 0
    buffer_load_dwordx4 v12, s[20:23], s63 offen  lds
    v_add_u32 v13, 40960, v2
    s_add_u32 m0, s64, 138240
    s_movk_i32 s63, 0
    buffer_load_dwordx4 v13, s[20:23], s63 offen  lds
    v_add_u32 v14, 81920, v1
    s_add_u32 m0, s64, 139264
    s_movk_i32 s63, 0
    buffer_load_dwordx4 v14, s[20:23], s63 offen  lds
    v_add_u32 v15, 81920, v2
    s_add_u32 m0, s64, 140288
    s_movk_i32 s63, 0
    buffer_load_dwordx4 v15, s[20:23], s63 offen  lds
    s_lshl_b32 s52, s56, 1
    s_add_u32 s52, s52, s54
    s_and_b32 s60, s53, 7
    s_add_u32 s62, s60, 1
    s_mul_i32 s62, s62, 3
    s_lshr_b32 s62, s62, 3
    s_mul_i32 s62, s62, 3
    s_add_u32 s62, s62, s67
    s_bitcmp1_b32 0xa5, s60
    s_cselect_b32 s71, s62, 99
    s_lshl_b32 s66, s49, 10
    s_add_u32 m0, s65, 0
    s_mov_b32 s63, 245760
    buffer_load_dwordx4 v16, s[24:27], s63 offen  lds
    s_add_u32 m0, s65, 1024
    s_mov_b32 s63, 245760
    buffer_load_dwordx4 v17, s[24:27], s63 offen  lds
    s_add_u32 m0, s65, 2048
    s_mov_b32 s63, 245760
    buffer_load_dwordx4 v18, s[24:27], s63 offen  lds
    s_add_u32 m0, s65, 3072
    s_mov_b32 s63, 245760
    buffer_load_dwordx4 v19, s[24:27], s63 offen  lds
    v_mov_b32 v40, 0
    v_mov_b32 v41, 0
    v_mov_b32 v9, 0
    v_mov_b32 v221, 0
    v_mov_b32 v222, 0
    v_mov_b32 v223, 0
    v_mov_b32 v224, 0
    v_mov_b32 v225, 0
    v_mov_b32 v226, 0
    v_mov_b32 v227, 0
    v_mov_b32 v228, 0
    v_mov_b32 v229, 0
    v_mov_b32 v230, 0
    v_mov_b32 v231, 0
    v_mov_b32 v232, 0
    v_mov_b32 v233, 0
    v_mov_b32 v234, 0
    s_mov_b32 s28, s8
    s_and_b32 s29, s9, 0xffff
    s_mov_b32 s30, 0xc8000
    s_mov_b32 s31, 0x20000
    s_mov_b32 s36, s12
    s_and_b32 s37, s13, 0xffff
    s_mov_b32 s38, 0x500000
    s_mov_b32 s39, 0x20000
    s_mov_b32 s40, s14
    s_and_b32 s41, s15, 0xffff
    s_mov_b32 s42, 0x100
    s_mov_b32 s43, 0x20000
    s_mov_b32 s44, s16
    s_and_b32 s45, s17, 0xffff
    s_mov_b32 s46, 0x10000000
    s_mov_b32 s47, 0x20000
    s_waitcnt vmcnt(4)
    s_barrier
    s_add_u32 m0, s64, 32768
    s_movk_i32 s63, 128
    buffer_load_dwordx4 v10, s[20:23], s63 offen  lds
    s_add_u32 m0, s64, 33792
    s_movk_i32 s63, 128
    buffer_load_dwordx4 v11, s[20:23], s63 offen  lds
    s_add_u32 m0, s64, 34816
    s_movk_i32 s63, 128
    buffer_load_dwordx4 v12, s[20:23], s63 offen  lds
    s_add_u32 m0, s64, 35840
    s_movk_i32 s63, 128
    buffer_load_dwordx4 v13, s[20:23], s63 offen  lds
    s_add_u32 m0, s64, 36864
    s_movk_i32 s63, 128
    buffer_load_dwordx4 v14, s[20:23], s63 offen  lds
    s_add_u32 m0, s64, 37888
    s_movk_i32 s63, 128
    buffer_load_dwordx4 v15, s[20:23], s63 offen  lds
    s_add_u32 m0, s65, 16384
    s_mov_b32 s63, 491520
    buffer_load_dwordx4 v16, s[24:27], s63 offen  lds
    s_add_u32 m0, s65, 17408
    s_mov_b32 s63, 491520
    buffer_load_dwordx4 v17, s[24:27], s63 offen  lds
    s_and_b32 s60, s53, 7
    s_mul_i32 s61, s60, 5
    s_lshr_b32 s61, s61, 3
    s_mul_i32 s61, s61, 3
    s_mul_i32 s60, s60, 3
    s_sub_u32 s60, s70, s60
    s_add_u32 s61, s61, s60
    s_cmp_lt_u32 s71, 12
    s_cselect_b32 s57, 99, s61
    s_cbranch_scc0 L_L_nowo
    s_add_u32 s62, s71, 8
    s_mul_i32 s60, s62, 52
    s_lshr_b32 s60, s60, 8
    s_mul_i32 s61, s60, 5
    s_sub_u32 s59, s62, s61
    s_mov_b32 s61, s59
    s_and_b32 s63, s50, 4
    s_add_u32 s60, s60, s63
    s_lshl_b32 s60, s60, 2
    s_add_u32 s60, s60, s49
    s_lshl_b32 s18, s60, 1
    s_bfe_u32 s19, s2, 0x10001
    s_and_b32 s60, s50, 1
    s_mul_i32 s60, s60, 5
    s_add_u32 s60, s60, s61
    s_lshl_b32 s58, s60, 7
    s_mov_b32 s59, 0
    s_add_u32 s60, s18, 0
    s_mul_i32 s63, s60, 373
    s_lshr_b32 s63, s63, 12
    s_mul_i32 s61, s63, 11
    s_sub_u32 s61, s60, s61
    s_add_u32 s61, s61, 1
    s_mul_i32 s61, s61, 86
    s_lshr_b32 s61, s61, 8
    s_lshl_b32 s63, s63, 1
    s_add_u32 s63, s63, s19
    s_lshl_b32 s63, s63, 2
    s_add_u32 s63, s63, s61
    s_lshl_b32 s63, s63, 8
    s_add_u32 s63, s63, 5898240
    v_mov_b32 v4, s63
    s_add_u32 s60, s18, 1
    s_mul_i32 s63, s60, 373
    s_lshr_b32 s63, s63, 12
    s_mul_i32 s61, s63, 11
    s_sub_u32 s61, s60, s61
    s_add_u32 s61, s61, 1
    s_mul_i32 s61, s61, 86
    s_lshr_b32 s61, s61, 8
    s_lshl_b32 s63, s63, 1
    s_add_u32 s63, s63, s19
    s_lshl_b32 s63, s63, 2
    s_add_u32 s63, s63, s61
    s_lshl_b32 s63, s63, 8
    s_add_u32 s63, s63, 5898240
    v_mov_b32 v5, s63
    v_cmp_gt_u32 vcc, 32, v0
    s_nop 1
    v_cndmask_b32 v9, v5, v4, vcc
    v_and_b32 v4, 1, v0
    v_bfe_u32 v4, v0, 4, 1
    s_and_b32 s60, s49, 1
    v_lshl_or_b32 v4, s60, 1, v4
    v_lshlrev_b32 v4, 1, v4
    v_and_b32 v5, 7, v0
    v_xor_b32 v4, v4, v5
    v_lshl_add_u32 v4, v4, 4, s58
    v_lshrrev_b32 v5, 5, v0
    v_bfe_u32 v6, v0, 3, 2
    v_mad_u32_u24 v40, v5, 20, v6
    s_lshl_b32 s61, s49, 2
    v_add_u32 v40, s61, v40
    v_mul_u32_u24 v40, 1280, v40
    v_add_u32 v40, v40, v4
    v_xor_b32 v5, s60, v5
    v_mad_u32_u24 v41, v5, 20, v6
    s_mul_i32 s61, s49, 40
    s_add_u32 s61, s61, 16
    v_add_u32 v41, s61, v41
    v_mul_u32_u24 v41, 1280, v41
    v_add_u32 v41, v41, v4
L_L_nowo:
    s_cmp_lt_u32 s71, 12
    s_cbranch_scc1 L_la_1
    s_add_u32 m0, s65, 18432
    s_mov_b32 s63, 491520
    buffer_load_dwordx4 v18, s[24:27], s63 offen  lds
    s_add_u32 m0, s65, 19456
    s_mov_b32 s63, 491520
    buffer_load_dwordx4 v19, s[24:27], s63 offen  lds
    s_waitcnt vmcnt(4)
    s_barrier
    s_branch L_lb_2
L_la_1:
    s_waitcnt vmcnt(2)
    s_barrier
    s_add_u32 m0, s65, 18432
    s_mov_b32 s63, 491520
    buffer_load_dwordx4 v18, s[24:27], s63 offen  lds
    s_add_u32 m0, s65, 19456
    s_mov_b32 s63, 491520
    buffer_load_dwordx4 v19, s[24:27], s63 offen  lds
L_lb_2:
    s_add_u32 m0, s64, 57344
    s_movk_i32 s63, 256
    buffer_load_dwordx4 v10, s[20:23], s63 offen  lds
    s_add_u32 m0, s64, 58368
    s_movk_i32 s63, 256
    buffer_load_dwordx4 v11, s[20:23], s63 offen  lds
    s_add_u32 m0, s64, 59392
    s_movk_i32 s63, 256
    buffer_load_dwordx4 v12, s[20:23], s63 offen  lds
    s_add_u32 m0, s64, 60416
    s_movk_i32 s63, 256
    buffer_load_dwordx4 v13, s[20:23], s63 offen  lds
    s_add_u32 m0, s64, 61440
    s_movk_i32 s63, 256
    buffer_load_dwordx4 v14, s[20:23], s63 offen  lds
    s_add_u32 m0, s64, 62464
    s_movk_i32 s63, 256
    buffer_load_dwordx4 v15, s[20:23], s63 offen  lds
    s_add_u32 m0, s65, 118784
    s_mov_b32 s63, 737280
    buffer_load_dwordx4 v16, s[24:27], s63 offen  lds
    s_add_u32 m0, s65, 119808
    s_mov_b32 s63, 737280
    buffer_load_dwordx4 v17, s[24:27], s63 offen  lds
    s_cmp_ge_u32 s57, 10
    s_cbranch_scc1 L_b2p_3
    s_cmp_ge_u32 s57, 5
    s_cselect_b32 s4, 1, 0
    s_mul_i32 s5, s4, 5
    s_sub_u32 s19, s57, s5
    s_lshl_b32 s5, s50, 1
    s_add_u32 s18, s4, s5
    s_lshl_b32 s4, s19, 11
    s_lshl_b32 s5, s18, 7
    s_add_u32 s4, s4, s5
    s_mul_i32 s5, s49, 819200
    s_add_u32 s4, s4, s5
    s_add_u32 s4, s4, 2621440
    s_mov_b32 s5, 51200
    s_lshl_b32 s3, s49, 8
    s_add_u32 s3, s3, 5910528
    v_and_b32 v234, 0, v0
    v_lshlrev_b32 v234, 7, v234
    v_add_u32 v73, 0, v0
    v_mul_u32_u24 v69, 1639, v73
    v_lshrrev_b32 v69, 16, v69
    v_mul_u32_u24 v70, 40, v69
    v_sub_u32 v70, v73, v70
    v_lshrrev_b32 v71, 3, v70
    v_mul_u32_u24 v71, 10240, v71
    v_and_b32 v70, 7, v70
    v_lshlrev_b32 v73, 1, v69
    v_and_b32 v73, 4, v73
    v_xor_b32 v70, v70, v73
    v_lshl_add_u32 v70, v70, 4, v71
    v_mul_u32_u24 v69, s5, v69
    v_add3_u32 v229, v69, v70, s4
    v_add_u32 v73, 64, v0
    v_mul_u32_u24 v69, 1639, v73
    v_lshrrev_b32 v69, 16, v69
    v_mul_u32_u24 v70, 40, v69
    v_sub_u32 v70, v73, v70
    v_lshrrev_b32 v71, 3, v70
    v_mul_u32_u24 v71, 10240, v71
    v_and_b32 v70, 7, v70
    v_lshlrev_b32 v73, 1, v69
    v_and_b32 v73, 4, v73
    v_xor_b32 v70, v70, v73
    v_lshl_add_u32 v70, v70, 4, v71
L_b2p_3:
    s_cmp_lt_u32 s71, 12
    s_cbranch_scc1 L_la_4
    s_add_u32 m0, s65, 120832
    s_mov_b32 s63, 737280
    buffer_load_dwordx4 v18, s[24:27], s63 offen  lds
    s_add_u32 m0, s65, 121856
    s_mov_b32 s63, 737280
    buffer_load_dwordx4 v19, s[24:27], s63 offen  lds
    s_waitcnt vmcnt(4)
    s_barrier
    s_branch L_lb_5
L_la_4:
    s_waitcnt vmcnt(2)
    s_barrier
    s_add_u32 m0, s65, 120832
    s_mov_b32 s63, 737280
    buffer_load_dwordx4 v18, s[24:27], s63 offen  lds
    s_add_u32 m0, s65, 121856
    s_mov_b32 s63, 737280
    buffer_load_dwordx4 v19, s[24:27], s63 offen  lds
L_lb_5:
    s_add_u32 m0, s64, 135168
    s_movk_i32 s63, 384
    buffer_load_dwordx4 v10, s[20:23], s63 offen  lds
    s_add_u32 m0, s64, 136192
    s_movk_i32 s63, 384
    buffer_load_dwordx4 v11, s[20:23], s63 offen  lds
    s_add_u32 m0, s64, 137216
    s_movk_i32 s63, 384
    buffer_load_dwordx4 v12, s[20:23], s63 offen  lds
    s_add_u32 m0, s64, 138240
    s_movk_i32 s63, 384
    buffer_load_dwordx4 v13, s[20:23], s63 offen  lds
    s_add_u32 m0, s64, 139264
    s_movk_i32 s63, 384
    buffer_load_dwordx4 v14, s[20:23], s63 offen  lds
    s_add_u32 m0, s64, 140288
    s_movk_i32 s63, 384
    buffer_load_dwordx4 v15, s[20:23], s63 offen  lds
    s_add_u32 m0, s65, 0
    s_mov_b32 s63, 983040
    buffer_load_dwordx4 v16, s[24:27], s63 offen  lds
    s_add_u32 m0, s65, 1024
    s_mov_b32 s63, 983040
    buffer_load_dwordx4 v17, s[24:27], s63 offen  lds
    s_cmp_ge_u32 s57, 10
    s_cbranch_scc1 L_b2p_6
    v_mul_u32_u24 v69, s5, v69
    v_add3_u32 v230, v69, v70, s4
    v_add_u32 v73, 128, v0
    v_mul_u32_u24 v69, 1639, v73
    v_lshrrev_b32 v69, 16, v69
    v_mul_u32_u24 v70, 40, v69
    v_sub_u32 v70, v73, v70
    v_lshrrev_b32 v71, 3, v70
    v_mul_u32_u24 v71, 10240, v71
    v_and_b32 v70, 7, v70
    v_lshlrev_b32 v73, 1, v69
    v_and_b32 v73, 4, v73
    v_xor_b32 v70, v70, v73
    v_lshl_add_u32 v70, v70, 4, v71
    v_mul_u32_u24 v69, s5, v69
    v_add3_u32 v231, v69, v70, s4
    v_add_u32 v73, 192, v0
    v_mul_u32_u24 v69, 1639, v73
    v_lshrrev_b32 v69, 16, v69
    v_mul_u32_u24 v70, 40, v69
    v_sub_u32 v70, v73, v70
    v_lshrrev_b32 v71, 3, v70
    v_mul_u32_u24 v71, 10240, v71
    v_and_b32 v70, 7, v70
    v_lshlrev_b32 v73, 1, v69
    v_and_b32 v73, 4, v73
    v_xor_b32 v70, v70, v73
    v_lshl_add_u32 v70, v70, 4, v71
    v_mul_u32_u24 v69, s5, v69
    v_add3_u32 v232, v69, v70, s4
    v_add_u32 v73, 256, v0
    v_mul_u32_u24 v69, 1639, v73
    v_lshrrev_b32 v69, 16, v69
    v_mul_u32_u24 v70, 40, v69
    v_sub_u32 v70, v73, v70
    v_lshrrev_b32 v71, 3, v70
    v_mul_u32_u24 v71, 10240, v71
    v_and_b32 v70, 7, v70
    v_lshlrev_b32 v73, 1, v69
    v_and_b32 v73, 4, v73
    v_xor_b32 v70, v70, v73
    v_lshl_add_u32 v70, v70, 4, v71
    v_mul_u32_u24 v69, s5, v69
L_b2p_6:
    s_cmp_lt_u32 s71, 12
    s_cbranch_scc1 L_la_7
    s_add_u32 m0, s65, 2048
    s_mov_b32 s63, 983040
    buffer_load_dwordx4 v18, s[24:27], s63 offen  lds
    s_add_u32 m0, s65, 3072
    s_mov_b32 s63, 983040
    buffer_load_dwordx4 v19, s[24:27], s63 offen  lds
    s_waitcnt vmcnt(4)
    s_barrier
    s_branch L_lb_8
L_la_7:
    s_waitcnt vmcnt(2)
    s_barrier
    s_add_u32 m0, s65, 2048
    s_mov_b32 s63, 983040
    buffer_load_dwordx4 v18, s[24:27], s63 offen  lds
    s_add_u32 m0, s65, 3072
    s_mov_b32 s63, 983040
    buffer_load_dwordx4 v19, s[24:27], s63 offen  lds
L_lb_8:
    s_add_u32 m0, s64, 32768
    s_movk_i32 s63, 512
    buffer_load_dwordx4 v10, s[20:23], s63 offen  lds
    s_add_u32 m0, s64, 33792
    s_movk_i32 s63, 512
    buffer_load_dwordx4 v11, s[20:23], s63 offen  lds
    s_add_u32 m0, s64, 34816
    s_movk_i32 s63, 512
    buffer_load_dwordx4 v12, s[20:23], s63 offen  lds
    s_add_u32 m0, s64, 35840
    s_movk_i32 s63, 512
    buffer_load_dwordx4 v13, s[20:23], s63 offen  lds
    s_add_u32 m0, s64, 36864
    s_movk_i32 s63, 512
    buffer_load_dwordx4 v14, s[20:23], s63 offen  lds
    s_add_u32 m0, s64, 37888
    s_movk_i32 s63, 512
    buffer_load_dwordx4 v15, s[20:23], s63 offen  lds
    s_add_u32 m0, s65, 16384
    s_mov_b32 s63, 1228800
    buffer_load_dwordx4 v16, s[24:27], s63 offen  lds
    s_add_u32 m0, s65, 17408
    s_mov_b32 s63, 1228800
    buffer_load_dwordx4 v17, s[24:27], s63 offen  lds
    s_cmp_ge_u32 s57, 10
    s_cbranch_scc1 L_b2p_9
    v_add3_u32 v233, v69, v70, s4
    s_and_b32 s4, s49, 1
    s_lshl_b32 s59, s18, 1
    s_add_u32 s59, s59, s4
    v_and_b32 v78, 15, v0
    v_lshrrev_b32 v79, 4, v0
    v_and_b32 v77, 1, v79
    v_cvt_f32_u32 v76, v77
    v_mul_f32 v75, 0xbe800000, v76
    v_sub_f32 v76, 0xbe800000, v75
    v_lshlrev_b32 v66, 2, v79
    v_cvt_f32_u32 v74, v66
    s_lshr_b32 s5, s49, 1
    s_lshl_b32 s7, s5, 5
    v_add_u32 v66, s7, v78
    v_add_u32 v66, 0, v66
    v_cvt_f32_u32 v66, v66
    v_mul_f32 v66, 0x3c800000, v66
    v_fma_f32 v71, v66, v74, v75
    v_fma_f32 v72, v66, v74, v76
    v_fmamk_f32 v67, v66, 0x0, v71
    v_fmamk_f32 v68, v66, 0x3f800000, v71
    v_fmamk_f32 v69, v66, 0x0, v72
    v_fmamk_f32 v70, v66, 0x3f800000, v72
    v_cos_f32 v67, v67
    v_cos_f32 v68, v68
    v_cos_f32 v69, v69
    v_cos_f32 v70, v70
    v_cvt_pk_bf16_f32 v32, v67, v68
    v_cvt_pk_bf16_f32 v34, v69, v70
    v_fmamk_f32 v67, v66, 0x40000000, v71
    v_fmamk_f32 v68, v66, 0x40400000, v71
    v_fmamk_f32 v69, v66, 0x40000000, v72
    v_fmamk_f32 v70, v66, 0x40400000, v72
    v_cos_f32 v67, v67
    v_cos_f32 v68, v68
    v_cos_f32 v69, v69
    v_cos_f32 v70, v70
    v_cvt_pk_bf16_f32 v33, v67, v68
    v_cvt_pk_bf16_f32 v35, v69, v70
    v_fmamk_f32 v67, v66, 0x41800000, v71
    v_fmamk_f32 v68, v66, 0x41880000, v71
    v_fmamk_f32 v69, v66, 0x41800000, v72
L_b2p_9:
    s_cmp_lt_u32 s71, 12
    s_cbranch_scc1 L_la_10
    s_add_u32 m0, s65, 18432
    s_mov_b32 s63, 1228800
    buffer_load_dwordx4 v18, s[24:27], s63 offen  lds
    s_add_u32 m0, s65, 19456
    s_mov_b32 s63, 1228800
    buffer_load_dwordx4 v19, s[24:27], s63 offen  lds
    s_waitcnt vmcnt(4)
    s_barrier
    s_branch L_lb_11
L_la_10:
    s_waitcnt vmcnt(2)
    s_barrier
    s_add_u32 m0, s65, 18432
    s_mov_b32 s63, 1228800
    buffer_load_dwordx4 v18, s[24:27], s63 offen  lds
    s_add_u32 m0, s65, 19456
    s_mov_b32 s63, 1228800
    buffer_load_dwordx4 v19, s[24:27], s63 offen  lds
L_lb_11:
    s_add_u32 m0, s64, 57344
    s_movk_i32 s63, 640
    buffer_load_dwordx4 v10, s[20:23], s63 offen  lds
    s_add_u32 m0, s64, 58368
    s_movk_i32 s63, 640
    buffer_load_dwordx4 v11, s[20:23], s63 offen  lds
    s_add_u32 m0, s64, 59392
    s_movk_i32 s63, 640
    buffer_load_dwordx4 v12, s[20:23], s63 offen  lds
    s_add_u32 m0, s64, 60416
    s_movk_i32 s63, 640
    buffer_load_dwordx4 v13, s[20:23], s63 offen  lds
    s_add_u32 m0, s64, 61440
    s_movk_i32 s63, 640
    buffer_load_dwordx4 v14, s[20:23], s63 offen  lds
    s_add_u32 m0, s64, 62464
    s_movk_i32 s63, 640
    buffer_load_dwordx4 v15, s[20:23], s63 offen  lds
    s_add_u32 m0, s65, 118784
    s_mov_b32 s63, 1474560
    buffer_load_dwordx4 v16, s[24:27], s63 offen  lds
    s_add_u32 m0, s65, 119808
    s_mov_b32 s63, 1474560
    buffer_load_dwordx4 v17, s[24:27], s63 offen  lds
    s_cmp_ge_u32 s57, 10
    s_cbranch_scc1 L_b2p_12
    v_fmamk_f32 v70, v66, 0x41880000, v72
    v_cos_f32 v67, v67
    v_cos_f32 v68, v68
    v_cos_f32 v69, v69
    v_cos_f32 v70, v70
    v_cvt_pk_bf16_f32 v36, v67, v68
    v_cvt_pk_bf16_f32 v38, v69, v70
    v_fmamk_f32 v67, v66, 0x41900000, v71
    v_fmamk_f32 v68, v66, 0x41980000, v71
    v_fmamk_f32 v69, v66, 0x41900000, v72
    v_fmamk_f32 v70, v66, 0x41980000, v72
    v_cos_f32 v67, v67
    v_cos_f32 v68, v68
    v_cos_f32 v69, v69
    v_cos_f32 v70, v70
    v_cvt_pk_bf16_f32 v37, v67, v68
    v_cvt_pk_bf16_f32 v39, v69, v70
    v_add_u32 v66, s7, v78
    v_add_u32 v66, 16, v66
    v_cvt_f32_u32 v66, v66
    v_mul_f32 v66, 0x3c800000, v66
    v_fma_f32 v71, v66, v74, v75
    v_fma_f32 v72, v66, v74, v76
    v_fmamk_f32 v67, v66, 0x0, v71
    v_fmamk_f32 v68, v66, 0x3f800000, v71
    v_fmamk_f32 v69, v66, 0x0, v72
    v_fmamk_f32 v70, v66, 0x3f800000, v72
    v_cos_f32 v67, v67
    v_cos_f32 v68, v68
    v_cos_f32 v69, v69
    v_cos_f32 v70, v70
    v_cvt_pk_bf16_f32 v48, v67, v68
    v_cvt_pk_bf16_f32 v50, v69, v70
    v_fmamk_f32 v67, v66, 0x40000000, v71
    v_fmamk_f32 v68, v66, 0x40400000, v71
    v_fmamk_f32 v69, v66, 0x40000000, v72
    v_fmamk_f32 v70, v66, 0x40400000, v72
    v_cos_f32 v67, v67
    v_cos_f32 v68, v68
    v_cos_f32 v69, v69
    v_cos_f32 v70, v70
    v_cvt_pk_bf16_f32 v49, v67, v68
    v_cvt_pk_bf16_f32 v51, v69, v70
L_b2p_12:
    s_cmp_lt_u32 s71, 12
    s_cbranch_scc1 L_la_13
    s_add_u32 m0, s65, 120832
    s_mov_b32 s63, 1474560
    buffer_load_dwordx4 v18, s[24:27], s63 offen  lds
    s_add_u32 m0, s65, 121856
    s_mov_b32 s63, 1474560
    buffer_load_dwordx4 v19, s[24:27], s63 offen  lds
    s_waitcnt vmcnt(4)
    s_barrier
    s_branch L_lb_14
L_la_13:
    s_waitcnt vmcnt(2)
    s_barrier
    s_add_u32 m0, s65, 120832
    s_mov_b32 s63, 1474560
    buffer_load_dwordx4 v18, s[24:27], s63 offen  lds
    s_add_u32 m0, s65, 121856
    s_mov_b32 s63, 1474560
    buffer_load_dwordx4 v19, s[24:27], s63 offen  lds
L_lb_14:
    s_add_u32 m0, s64, 135168
    s_movk_i32 s63, 768
    buffer_load_dwordx4 v10, s[20:23], s63 offen  lds
    s_add_u32 m0, s64, 136192
    s_movk_i32 s63, 768
    buffer_load_dwordx4 v11, s[20:23], s63 offen  lds
    s_add_u32 m0, s64, 137216
    s_movk_i32 s63, 768
    buffer_load_dwordx4 v12, s[20:23], s63 offen  lds
    s_add_u32 m0, s64, 138240
    s_movk_i32 s63, 768
    buffer_load_dwordx4 v13, s[20:23], s63 offen  lds
    s_add_u32 m0, s64, 139264
    s_movk_i32 s63, 768
    buffer_load_dwordx4 v14, s[20:23], s63 offen  lds
    s_add_u32 m0, s64, 140288
    s_movk_i32 s63, 768
    buffer_load_dwordx4 v15, s[20:23], s63 offen  lds
    s_add_u32 m0, s65, 0
    s_mov_b32 s63, 1720320
    buffer_load_dwordx4 v16, s[24:27], s63 offen  lds
    s_add_u32 m0, s65, 1024
    s_mov_b32 s63, 1720320
    buffer_load_dwordx4 v17, s[24:27], s63 offen  lds
    s_cmp_ge_u32 s57, 10
    s_cbranch_scc1 L_b2p_15
    v_fmamk_f32 v67, v66, 0x41800000, v71
    v_fmamk_f32 v68, v66, 0x41880000, v71
    v_fmamk_f32 v69, v66, 0x41800000, v72
    v_fmamk_f32 v70, v66, 0x41880000, v72
    v_cos_f32 v67, v67
    v_cos_f32 v68, v68
    v_cos_f32 v69, v69
    v_cos_f32 v70, v70
    v_cvt_pk_bf16_f32 v52, v67, v68
    v_cvt_pk_bf16_f32 v54, v69, v70
    v_fmamk_f32 v67, v66, 0x41900000, v71
    v_fmamk_f32 v68, v66, 0x41980000, v71
    v_fmamk_f32 v69, v66, 0x41900000, v72
    v_fmamk_f32 v70, v66, 0x41980000, v72
    v_cos_f32 v67, v67
    v_cos_f32 v68, v68
    v_cos_f32 v69, v69
    v_cos_f32 v70, v70
    v_cvt_pk_bf16_f32 v53, v67, v68
    v_cvt_pk_bf16_f32 v55, v69, v70
    v_and_b32 v65, 1, v0
    v_mul_u32_u24 v65, 0x8000, v65
    v_lshl_or_b32 v65, v65, 16, v65
    v_xor_b32 v40, v65, v32
    v_xor_b32 v41, v65, v33
    v_xor_b32 v42, v65, v34
    v_xor_b32 v43, v65, v35
    v_xor_b32 v44, v65, v36
    v_xor_b32 v45, v65, v37
    v_xor_b32 v46, v65, v38
    v_xor_b32 v47, v65, v39
    v_xor_b32 v56, v65, v48
    v_xor_b32 v57, v65, v49
    v_xor_b32 v58, v65, v50
    v_xor_b32 v59, v65, v51
    v_xor_b32 v60, v65, v52
    v_xor_b32 v61, v65, v53
    v_xor_b32 v62, v65, v54
    v_xor_b32 v63, v65, v55
    v_bfe_u32 v65, v0, 2, 2
    v_lshrrev_b32 v67, 1, v65
    v_xor_b32 v67, s4, v67
    v_lshl_add_u32 v65, v79, 2, v65
L_b2p_15:
    s_cmp_lt_u32 s71, 12
    s_cbranch_scc1 L_la_16
    s_add_u32 m0, s65, 2048
    s_mov_b32 s63, 1720320
    buffer_load_dwordx4 v18, s[24:27], s63 offen  lds
    s_add_u32 m0, s65, 3072
    s_mov_b32 s63, 1720320
    buffer_load_dwordx4 v19, s[24:27], s63 offen  lds
    s_waitcnt vmcnt(4)
    s_barrier
    s_branch L_lb_17
L_la_16:
    s_waitcnt vmcnt(2)
    s_barrier
    s_add_u32 m0, s65, 2048
    s_mov_b32 s63, 1720320
    buffer_load_dwordx4 v18, s[24:27], s63 offen  lds
    s_add_u32 m0, s65, 3072
    s_mov_b32 s63, 1720320
    buffer_load_dwordx4 v19, s[24:27], s63 offen  lds
L_lb_17:
    s_add_u32 m0, s64, 32768
    s_movk_i32 s63, 896
    buffer_load_dwordx4 v10, s[20:23], s63 offen  lds
    s_add_u32 m0, s64, 33792
    s_movk_i32 s63, 896
    buffer_load_dwordx4 v11, s[20:23], s63 offen  lds
    s_add_u32 m0, s64, 34816
    s_movk_i32 s63, 896
    buffer_load_dwordx4 v12, s[20:23], s63 offen  lds
    s_add_u32 m0, s64, 35840
    s_movk_i32 s63, 896
    buffer_load_dwordx4 v13, s[20:23], s63 offen  lds
    s_add_u32 m0, s64, 36864
    s_movk_i32 s63, 896
    buffer_load_dwordx4 v14, s[20:23], s63 offen  lds
    s_add_u32 m0, s64, 37888
    s_movk_i32 s63, 896
    buffer_load_dwordx4 v15, s[20:23], s63 offen  lds
    s_add_u32 m0, s65, 16384
    s_mov_b32 s63, 1966080
    buffer_load_dwordx4 v16, s[24:27], s63 offen  lds
    s_add_u32 m0, s65, 17408
    s_mov_b32 s63, 1966080
    buffer_load_dwordx4 v17, s[24:27], s63 offen  lds
    s_cmp_ge_u32 s57, 10
    s_cbranch_scc1 L_b2p_18
    v_mul_u32_u24 v65, 640, v65
    v_lshl_add_u32 v65, v67, 6, v65
    v_and_b32 v66, 3, v0
    v_lshl_add_u32 v65, v66, 4, v65
    v_lshl_add_u32 v65, v77, 3, v65
    v_add_u32 v221, 0, v65
    v_xor_b32 v222, 8, v221
    s_lshl_b32 s7, s49, 12
    s_add_u32 s7, s7, 40960
    v_lshlrev_b32 v65, 1, v79
    v_and_b32 v66, 7, v78
    v_xor_b32 v65, v65, v66
    v_lshlrev_b32 v65, 4, v65
    v_lshl_add_u32 v65, v78, 7, v65
    v_add_u32 v223, s7, v65
    v_xor_b32 v224, 16, v223
    v_lshrrev_b32 v65, 3, v0
    v_and_b32 v66, 7, v0
    v_xor_b32 v67, v65, v66
    v_lshlrev_b32 v67, 4, v67
    v_lshl_add_u32 v67, v65, 7, v67
    v_add_u32 v225, s7, v67
    s_lshl_b32 s5, s5, 10
    s_add_u32 s5, s5, s59
    v_lshl_add_u32 v65, v65, 5, s5
    v_lshlrev_b32 v66, 4, v66
    s_lshl_b32 s4, s19, 7
    s_add_u32 s5, s4, 1280
    s_sub_u32 s4, 2432, s4
    v_mul_u32_u24 v67, 2560, v65
    v_add3_u32 v226, v67, v66, s5
    v_sub_u32 v67, 1280, v65
    v_mul_u32_u24 v67, 2560, v67
    v_add3_u32 v227, v67, v66, s4
    v_sub_u32 v67, 2048, v65
    v_and_b32 v67, 2047, v67
    v_mul_u32_u24 v67, 2560, v67
    v_add3_u32 v228, v67, v66, s4
L_b2p_18:
    s_cmp_lt_u32 s71, 12
    s_cbranch_scc1 L_la_19
    s_add_u32 m0, s65, 18432
    s_mov_b32 s63, 1966080
    buffer_load_dwordx4 v18, s[24:27], s63 offen  lds
    s_add_u32 m0, s65, 19456
    s_mov_b32 s63, 1966080
    buffer_load_dwordx4 v19, s[24:27], s63 offen  lds
    s_waitcnt vmcnt(4)
    s_barrier
    s_branch L_lb_20
L_la_19:
    s_waitcnt vmcnt(2)
    s_barrier
    s_add_u32 m0, s65, 18432
    s_mov_b32 s63, 1966080
    buffer_load_dwordx4 v18, s[24:27], s63 offen  lds
    s_add_u32 m0, s65, 19456
    s_mov_b32 s63, 1966080
    buffer_load_dwordx4 v19, s[24:27], s63 offen  lds
L_lb_20:
    s_add_u32 m0, s64, 57344
    s_movk_i32 s63, 1024
    buffer_load_dwordx4 v10, s[20:23], s63 offen  lds
    s_add_u32 m0, s64, 58368
    s_movk_i32 s63, 1024
    buffer_load_dwordx4 v11, s[20:23], s63 offen  lds
    s_add_u32 m0, s64, 59392
    s_movk_i32 s63, 1024
    buffer_load_dwordx4 v12, s[20:23], s63 offen  lds
    s_add_u32 m0, s64, 60416
    s_movk_i32 s63, 1024
    buffer_load_dwordx4 v13, s[20:23], s63 offen  lds
    s_add_u32 m0, s64, 61440
    s_movk_i32 s63, 1024
    buffer_load_dwordx4 v14, s[20:23], s63 offen  lds
    s_add_u32 m0, s64, 62464
    s_movk_i32 s63, 1024
    buffer_load_dwordx4 v15, s[20:23], s63 offen  lds
    s_add_u32 m0, s65, 118784
    s_mov_b32 s63, 2211840
    buffer_load_dwordx4 v16, s[24:27], s63 offen  lds
    s_add_u32 m0, s65, 119808
    s_mov_b32 s63, 2211840
    buffer_load_dwordx4 v17, s[24:27], s63 offen  lds
    s_cmp_lt_u32 s71, 12
    s_cbranch_scc1 L_la_21
    s_add_u32 m0, s65, 120832
    s_mov_b32 s63, 2211840
    buffer_load_dwordx4 v18, s[24:27], s63 offen  lds
    s_add_u32 m0, s65, 121856
    s_mov_b32 s63, 2211840
    buffer_load_dwordx4 v19, s[24:27], s63 offen  lds
    s_waitcnt vmcnt(4)
    s_barrier
    s_branch L_lb_22
L_la_21:
    s_waitcnt vmcnt(2)
    s_barrier
    s_add_u32 m0, s65, 120832
    s_mov_b32 s63, 2211840
    buffer_load_dwordx4 v18, s[24:27], s63 offen  lds
    s_add_u32 m0, s65, 121856
    s_mov_b32 s63, 2211840
    buffer_load_dwordx4 v19, s[24:27], s63 offen  lds
L_lb_22:
    s_add_u32 m0, s64, 135168
    s_movk_i32 s63, 1152
    buffer_load_dwordx4 v10, s[20:23], s63 offen  lds
    s_add_u32 m0, s64, 136192
    s_movk_i32 s63, 1152
    buffer_load_dwordx4 v11, s[20:23], s63 offen  lds
    s_add_u32 m0, s64, 137216
    s_movk_i32 s63, 1152
    buffer_load_dwordx4 v12, s[20:23], s63 offen  lds
    s_add_u32 m0, s64, 138240
    s_movk_i32 s63, 1152
    buffer_load_dwordx4 v13, s[20:23], s63 offen  lds
    s_add_u32 m0, s64, 139264
    s_movk_i32 s63, 1152
    buffer_load_dwordx4 v14, s[20:23], s63 offen  lds
    s_add_u32 m0, s64, 140288
    s_movk_i32 s63, 1152
    buffer_load_dwordx4 v15, s[20:23], s63 offen  lds
    v_mov_b32 v3, 0
    buffer_load_dword v2, v3, s[40:43], 0 offen sc1
    s_cmp_lt_u32 s71, 12
    s_cbranch_scc0 L_L_noe0
    s_add_u32 m0, s66, 0
    s_mov_b32 s63, 0
    buffer_load_dwordx4 v40, s[28:31], s63 offen lds
    s_add_u32 m0, s66, 4096
    s_mov_b32 s63, 51200
    buffer_load_dwordx4 v40, s[28:31], s63 offen lds
    s_add_u32 m0, s66, 8192
    s_mov_b32 s63, 102400
    buffer_load_dwordx4 v40, s[28:31], s63 offen lds
    s_add_u32 m0, s66, 12288
    s_mov_b32 s63, 153600
    buffer_load_dwordx4 v40, s[28:31], s63 offen lds
    s_add_u32 m0, s66, 32768
    s_mov_b32 s63, 409600
    buffer_load_dwordx4 v40, s[28:31], s63 offen lds
    s_add_u32 m0, s66, 36864
    s_mov_b32 s63, 460800
    buffer_load_dwordx4 v40, s[28:31], s63 offen lds
    s_add_u32 m0, s66, 40960
    s_mov_b32 s63, 512000
    buffer_load_dwordx4 v40, s[28:31], s63 offen lds
    s_add_u32 m0, s66, 45056
    s_mov_b32 s63, 563200
    buffer_load_dwordx4 v40, s[28:31], s63 offen lds
    s_waitcnt vmcnt(9)
L_L_noe0:
    s_cmp_lt_u32 s71, 12
    s_cbranch_scc1 L_L_nof0
    s_waitcnt vmcnt(1)
L_L_nof0:
    s_barrier
    s_cmp_lt_u32 s71, 12
    s_cbranch_scc0 L_L_b2
    v_mov_b32 v8, 159744
    s_mov_b32 s69, 0
L_ls_23:
    ds_read_b128 v[4:7], v8
    s_add_u32 s69, s69, 1
    s_cmp_gt_u32 s69, 1048576
    s_cbranch_scc1 L_lsok_24
    s_waitcnt lgkmcnt(0)
    v_and_b32 v4, v4, v5
    v_and_b32 v6, v6, v7
    v_and_b32 v4, v4, v6
    v_cmp_ne_u32 vcc, 1, v4
    s_cbranch_vccz L_lsok_24
    s_branch L_ls_23
L_lsok_24:
    s_waitcnt lgkmcnt(0)
    s_add_u32 m0, s66, 16384
    s_mov_b32 s63, 204800
    buffer_load_dwordx4 v40, s[28:31], s63 offen lds
    s_add_u32 m0, s66, 20480
    s_mov_b32 s63, 256000
    buffer_load_dwordx4 v40, s[28:31], s63 offen lds
    s_add_u32 m0, s66, 24576
    s_mov_b32 s63, 307200
    buffer_load_dwordx4 v40, s[28:31], s63 offen lds
    s_add_u32 m0, s66, 28672
    s_mov_b32 s63, 358400
    buffer_load_dwordx4 v40, s[28:31], s63 offen lds
    s_add_u32 m0, s66, 49152
    s_mov_b32 s63, 614400
    buffer_load_dwordx4 v40, s[28:31], s63 offen lds
    s_add_u32 m0, s66, 53248
    s_mov_b32 s63, 665600
    buffer_load_dwordx4 v40, s[28:31], s63 offen lds
    s_add_u32 m0, s66, 57344
    s_mov_b32 s63, 716800
    buffer_load_dwordx4 v40, s[28:31], s63 offen lds
    s_add_u32 m0, s66, 61440
    s_mov_b32 s63, 768000
    buffer_load_dwordx4 v40, s[28:31], s63 offen lds
    s_add_u32 m0, s66, 65536
    s_mov_b32 s63, 0
    buffer_load_dwordx4 v41, s[28:31], s63 offen lds
    s_add_u32 m0, s66, 69632
    s_mov_b32 s63, 204800
    buffer_load_dwordx4 v41, s[28:31], s63 offen lds
    s_add_u32 m0, s66, 73728
    s_mov_b32 s63, 409600
    buffer_load_dwordx4 v41, s[28:31], s63 offen lds
    s_add_u32 m0, s66, 77824
    s_mov_b32 s63, 614400
    buffer_load_dwordx4 v41, s[28:31], s63 offen lds
    s_waitcnt vmcnt(0)
    s_lshl_b32 s69, s49, 2
    s_add_u32 s69, s69, 159776
    v_mov_b32 v4, s69
    v_mov_b32 v5, 1
    ds_write_b32 v4, v5
    s_mov_b32 s69, 0
L_dbg_25:
    v_cmp_ne_u32 vcc, 1, v2
    s_cbranch_vccz L_dbgok_26
    s_add_u32 s69, s69, 1
    s_cmp_gt_u32 s69, 1048576
    s_cbranch_scc1 L_dbgok_26
    buffer_load_dword v2, v3, s[40:43], 0 offen sc1
    s_waitcnt vmcnt(0)
    s_branch L_dbg_25
L_dbgok_26:
    v_mov_b32 v8, 159776
    s_mov_b32 s69, 0
L_ls_27:
    ds_read_b128 v[4:7], v8
    s_add_u32 s69, s69, 1
    s_cmp_gt_u32 s69, 1048576
    s_cbranch_scc1 L_lsok_28
    s_waitcnt lgkmcnt(0)
    v_and_b32 v4, v4, v5
    v_and_b32 v6, v6, v7
    v_and_b32 v4, v4, v6
    v_cmp_ne_u32 vcc, 1, v4
    s_cbranch_vccz L_lsok_28
    s_branch L_ls_27
L_lsok_28:
    s_waitcnt lgkmcnt(0)
    s_branch L_A2
L_L_b2:
    s_cmp_ge_u32 s57, 10
    s_cbranch_scc1 L_fin
    s_mul_i32 s62, s49, 10240
    s_waitcnt vmcnt(0)
    s_mov_b32 s69, 0
L_dbg_29:
    v_cmp_ne_u32 vcc, 1, v2
    s_cbranch_vccz L_dbgok_30
    s_add_u32 s69, s69, 1
    s_cmp_gt_u32 s69, 1048576
    s_cbranch_scc1 L_dbgok_30
    buffer_load_dword v2, v3, s[40:43], 0 offen sc1
    s_waitcnt vmcnt(0)
    s_branch L_dbg_29
L_dbgok_30:
    v_mov_b32 v12, 159792
    s_mov_b32 s69, 0
L_ls_31:
    ds_read_b128 v[8:11], v12
    s_add_u32 s69, s69, 1
    s_cmp_gt_u32 s69, 1048576
    s_cbranch_scc1 L_lsok_32
    s_waitcnt lgkmcnt(0)
    v_and_b32 v8, v8, v9
    v_and_b32 v10, v10, v11
    v_and_b32 v8, v8, v10
    v_cmp_ne_u32 vcc, 1, v8
    s_cbranch_vccz L_lsok_32
    s_branch L_ls_31
L_lsok_32:
    s_waitcnt lgkmcnt(0)
    s_mov_b32 s69, 0
L_poll_33:
    buffer_load_dword v4, v234, s[44:47], s3 offen offset:128 sc1
    s_add_u32 s69, s69, 1
    s_cmp_gt_u32 s69, 1048576
    s_cbranch_scc1 L_pollok_34
    s_waitcnt vmcnt(0)
    v_cmp_ne_u32 vcc, 1, v4
    s_cbranch_vccnz L_poll_33
L_pollok_34:
    s_waitcnt vmcnt(0)
    s_add_u32 m0, s62, 0
    s_mov_b32 s63, 0
    buffer_load_dwordx4 v229, s[44:47], s63 offen sc1  lds
    s_add_u32 m0, s62, 1024
    s_mov_b32 s63, 0
    buffer_load_dwordx4 v230, s[44:47], s63 offen sc1  lds
    s_add_u32 m0, s62, 2048
    s_mov_b32 s63, 0
    buffer_load_dwordx4 v231, s[44:47], s63 offen sc1  lds
    s_add_u32 m0, s62, 3072
    s_mov_b32 s63, 0
    buffer_load_dwordx4 v232, s[44:47], s63 offen sc1  lds
    s_add_u32 m0, s62, 4096
    s_mov_b32 s63, 0
    buffer_load_dwordx4 v233, s[44:47], s63 offen sc1  lds
    s_add_u32 m0, s62, 5120
    s_mov_b32 s63, 409600
    buffer_load_dwordx4 v229, s[44:47], s63 offen sc1  lds
    s_add_u32 m0, s62, 6144
    s_mov_b32 s63, 409600
    buffer_load_dwordx4 v230, s[44:47], s63 offen sc1  lds
    s_add_u32 m0, s62, 7168
    s_mov_b32 s63, 409600
    buffer_load_dwordx4 v231, s[44:47], s63 offen sc1  lds
    s_add_u32 m0, s62, 8192
    s_mov_b32 s63, 409600
    buffer_load_dwordx4 v232, s[44:47], s63 offen sc1  lds
    s_add_u32 m0, s62, 9216
    s_mov_b32 s63, 409600
    buffer_load_dwordx4 v233, s[44:47], s63 offen sc1  lds
    s_waitcnt vmcnt(0)
    s_lshl_b32 s69, s49, 2
    s_add_u32 s69, s69, 159760
    v_mov_b32 v2, s69
    v_mov_b32 v3, 1
    ds_write_b32 v2, v3
    v_mov_b32 v12, 159760
    s_mov_b32 s69, 0
L_ls_35:
    ds_read_b128 v[8:11], v12
    s_add_u32 s69, s69, 1
    s_cmp_gt_u32 s69, 1048576
    s_cbranch_scc1 L_lsok_36
    s_waitcnt lgkmcnt(0)
    v_and_b32 v8, v8, v9
    v_and_b32 v10, v10, v11
    v_and_b32 v8, v8, v10
    v_cmp_ne_u32 vcc, 1, v8
    s_cbranch_vccz L_lsok_36
    s_branch L_ls_35
L_lsok_36:
    s_waitcnt lgkmcnt(0)
    ds_read_b64_tr_b16 v[104:105], v221 offset:0
    ds_read_b64_tr_b16 v[106:107], v222 offset:0
    ds_read_b64_tr_b16 v[108:109], v221 offset:128
    ds_read_b64_tr_b16 v[110:111], v222 offset:128
    ds_read_b64_tr_b16 v[112:113], v221 offset:256
    ds_read_b64_tr_b16 v[114:115], v222 offset:256
    ds_read_b64_tr_b16 v[116:117], v221 offset:384
    ds_read_b64_tr_b16 v[118:119], v222 offset:384
    ds_read_b64_tr_b16 v[120:121], v221 offset:512
    ds_read_b64_tr_b16 v[122:123], v222 offset:512
    ds_read_b64_tr_b16 v[124:125], v221 offset:10240
    ds_read_b64_tr_b16 v[126:127], v222 offset:10240
    ds_read_b64_tr_b16 v[128:129], v221 offset:10368
    ds_read_b64_tr_b16 v[130:131], v222 offset:10368
    s_waitcnt lgkmcnt(12)
    v_mfma_f32_16x16x32_bf16 v[64:67], v[104:107], v[32:35], 0
    ds_read_b64_tr_b16 v[132:133], v221 offset:10496
    v_mfma_f32_16x16x32_bf16 v[68:71], v[104:107], v[48:51], 0
    ds_read_b64_tr_b16 v[134:135], v222 offset:10496
    s_waitcnt lgkmcnt(12)
    v_mfma_f32_16x16x32_bf16 v[72:75], v[108:111], v[32:35], 0
    ds_read_b64_tr_b16 v[136:137], v221 offset:10624
    v_mfma_f32_16x16x32_bf16 v[76:79], v[108:111], v[48:51], 0
    ds_read_b64_tr_b16 v[138:139], v222 offset:10624
    s_waitcnt lgkmcnt(12)
    v_mfma_f32_16x16x32_bf16 v[80:83], v[112:115], v[32:35], 0
    ds_read_b64_tr_b16 v[140:141], v221 offset:10752
    v_mfma_f32_16x16x32_bf16 v[84:87], v[112:115], v[48:51], 0
    ds_read_b64_tr_b16 v[142:143], v222 offset:10752
    s_waitcnt lgkmcnt(12)
    v_mfma_f32_16x16x32_bf16 v[88:91], v[116:119], v[32:35], 0
    ds_read_b64_tr_b16 v[104:105], v221 offset:20480
    v_mfma_f32_16x16x32_bf16 v[92:95], v[116:119], v[48:51], 0
    ds_read_b64_tr_b16 v[106:107], v222 offset:20480
    s_waitcnt lgkmcnt(12)
    v_mfma_f32_16x16x32_bf16 v[96:99], v[120:123], v[32:35], 0
    ds_read_b64_tr_b16 v[108:109], v221 offset:20608
    v_mfma_f32_16x16x32_bf16 v[100:103], v[120:123], v[48:51], 0
    ds_read_b64_tr_b16 v[110:111], v222 offset:20608
    s_waitcnt lgkmcnt(12)
    v_mfma_f32_16x16x32_bf16 v[64:67], v[124:127], v[36:39], v[64:67]
    ds_read_b64_tr_b16 v[112:113], v221 offset:20736
    v_mfma_f32_16x16x32_bf16 v[68:71], v[124:127], v[52:55], v[68:71]
    ds_read_b64_tr_b16 v[114:115], v222 offset:20736
    s_waitcnt lgkmcnt(12)
    v_mfma_f32_16x16x32_bf16 v[72:75], v[128:131], v[36:39], v[72:75]
    ds_read_b64_tr_b16 v[116:117], v221 offset:20864
    v_mfma_f32_16x16x32_bf16 v[76:79], v[128:131], v[52:55], v[76:79]
    ds_read_b64_tr_b16 v[118:119], v222 offset:20864
    s_waitcnt lgkmcnt(12)
    v_mfma_f32_16x16x32_bf16 v[80:83], v[132:135], v[36:39], v[80:83]
    ds_read_b64_tr_b16 v[120:121], v221 offset:20992
    v_mfma_f32_16x16x32_bf16 v[84:87], v[132:135], v[52:55], v[84:87]
    ds_read_b64_tr_b16 v[122:123], v222 offset:20992
    s_waitcnt lgkmcnt(12)
    v_mfma_f32_16x16x32_bf16 v[88:91], v[136:139], v[36:39], v[88:91]
    ds_read_b64_tr_b16 v[124:125], v221 offset:30720
    v_mfma_f32_16x16x32_bf16 v[92:95], v[136:139], v[52:55], v[92:95]
    ds_read_b64_tr_b16 v[126:127], v222 offset:30720
    s_waitcnt lgkmcnt(12)
    v_mfma_f32_16x16x32_bf16 v[96:99], v[140:143], v[36:39], v[96:99]
    ds_read_b64_tr_b16 v[128:129], v221 offset:30848
    v_mfma_f32_16x16x32_bf16 v[100:103], v[140:143], v[52:55], v[100:103]
    ds_read_b64_tr_b16 v[130:131], v222 offset:30848
    s_waitcnt lgkmcnt(12)
    v_mfma_f32_16x16x32_bf16 v[64:67], v[104:107], v[40:43], v[64:67]
    ds_read_b64_tr_b16 v[132:133], v221 offset:30976
    v_mfma_f32_16x16x32_bf16 v[68:71], v[104:107], v[56:59], v[68:71]
    ds_read_b64_tr_b16 v[134:135], v222 offset:30976
    s_waitcnt lgkmcnt(12)
    v_mfma_f32_16x16x32_bf16 v[72:75], v[108:111], v[40:43], v[72:75]
    ds_read_b64_tr_b16 v[136:137], v221 offset:31104
    v_mfma_f32_16x16x32_bf16 v[76:79], v[108:111], v[56:59], v[76:79]
    ds_read_b64_tr_b16 v[138:139], v222 offset:31104
    s_waitcnt lgkmcnt(12)
    v_mfma_f32_16x16x32_bf16 v[80:83], v[112:115], v[40:43], v[80:83]
    ds_read_b64_tr_b16 v[140:141], v221 offset:31232
    v_mfma_f32_16x16x32_bf16 v[84:87], v[112:115], v[56:59], v[84:87]
    ds_read_b64_tr_b16 v[142:143], v222 offset:31232
    s_waitcnt lgkmcnt(12)
    v_mfma_f32_16x16x32_bf16 v[88:91], v[116:119], v[40:43], v[88:91]
    v_mfma_f32_16x16x32_bf16 v[92:95], v[116:119], v[56:59], v[92:95]
    s_waitcnt lgkmcnt(10)
    v_mfma_f32_16x16x32_bf16 v[96:99], v[120:123], v[40:43], v[96:99]
    v_mfma_f32_16x16x32_bf16 v[100:103], v[120:123], v[56:59], v[100:103]
    s_waitcnt lgkmcnt(8)
    v_mfma_f32_16x16x32_bf16 v[64:67], v[124:127], v[44:47], v[64:67]
    v_mfma_f32_16x16x32_bf16 v[68:71], v[124:127], v[60:63], v[68:71]
    s_waitcnt lgkmcnt(6)
    v_mfma_f32_16x16x32_bf16 v[72:75], v[128:131], v[44:47], v[72:75]
    v_mfma_f32_16x16x32_bf16 v[76:79], v[128:131], v[60:63], v[76:79]
    s_waitcnt lgkmcnt(4)
    v_mfma_f32_16x16x32_bf16 v[80:83], v[132:135], v[44:47], v[80:83]
    v_mfma_f32_16x16x32_bf16 v[84:87], v[132:135], v[60:63], v[84:87]
    s_waitcnt lgkmcnt(2)
    v_mfma_f32_16x16x32_bf16 v[88:91], v[136:139], v[44:47], v[88:91]
    v_mfma_f32_16x16x32_bf16 v[92:95], v[136:139], v[60:63], v[92:95]
    s_waitcnt lgkmcnt(0)
    v_mfma_f32_16x16x32_bf16 v[96:99], v[140:143], v[44:47], v[96:99]
    v_mfma_f32_16x16x32_bf16 v[100:103], v[140:143], v[60:63], v[100:103]
    v_xor_b32 v1, 96, v223
    v_xor_b32 v2, 96, v224
    v_cvt_pk_bf16_f32 v144, v64, v72
    s_nop 0
    v_cvt_pk_bf16_f32 v145, v80, v88
    v_cvt_pk_bf16_f32 v146, v65, v73
    v_cvt_pk_bf16_f32 v147, v81, v89
    v_cvt_pk_bf16_f32 v148, v66, v74
    v_cvt_pk_bf16_f32 v149, v82, v90
    v_cvt_pk_bf16_f32 v150, v67, v75
    v_cvt_pk_bf16_f32 v151, v83, v91
    ds_write_b128 v223, v[144:147]
    ds_write_b128 v224, v[148:151]
    v_cvt_pk_bf16_f32 v152, v99, v91
    v_cvt_pk_bf16_f32 v153, v83, v75
    v_cvt_pk_bf16_f32 v154, v98, v90
    v_cvt_pk_bf16_f32 v155, v82, v74
    v_cvt_pk_bf16_f32 v156, v97, v89
    v_cvt_pk_bf16_f32 v157, v81, v73
    v_cvt_pk_bf16_f32 v158, v96, v88
    v_cvt_pk_bf16_f32 v159, v80, v72
    ds_write_b128 v1, v[152:155] offset:2048
    ds_write_b128 v2, v[156:159] offset:2048
    ds_read_b128 v[176:179], v225 offset:0
    ds_read_b128 v[180:183], v225 offset:1024
    ds_read_b128 v[184:187], v225 offset:2048
    ds_read_b128 v[188:191], v225 offset:3072
    v_cvt_pk_bf16_f32 v160, v68, v76
    v_cvt_pk_bf16_f32 v161, v84, v92
    v_cvt_pk_bf16_f32 v162, v69, v77
    v_cvt_pk_bf16_f32 v163, v85, v93
    v_cvt_pk_bf16_f32 v164, v70, v78
    v_cvt_pk_bf16_f32 v165, v86, v94
    v_cvt_pk_bf16_f32 v166, v71, v79
    v_cvt_pk_bf16_f32 v167, v87, v95
    ds_write_b128 v223, v[160:163]
    ds_write_b128 v224, v[164:167]
    v_cvt_pk_bf16_f32 v168, v103, v95
    v_cvt_pk_bf16_f32 v169, v87, v79
    v_cvt_pk_bf16_f32 v170, v102, v94
    v_cvt_pk_bf16_f32 v171, v86, v78
    v_cvt_pk_bf16_f32 v172, v101, v93
    v_cvt_pk_bf16_f32 v173, v85, v77
    v_cvt_pk_bf16_f32 v174, v100, v92
    v_cvt_pk_bf16_f32 v175, v84, v76
    ds_write_b128 v1, v[168:171] offset:2048
    ds_write_b128 v2, v[172:175] offset:2048
    ds_read_b128 v[192:195], v225 offset:0
    ds_read_b128 v[196:199], v225 offset:1024
    ds_read_b128 v[200:203], v225 offset:2048
    ds_read_b128 v[204:207], v225 offset:3072
    s_waitcnt lgkmcnt(8)
    s_mov_b32 s60, 0
    buffer_store_dwordx4 v[176:179], v226, s[36:39], s60 offen sc1
    s_mov_b32 s60, 655360
    buffer_store_dwordx4 v[180:183], v226, s[36:39], s60 offen sc1
    buffer_store_dwordx4 v[184:187], v228, s[36:39], 0 offen sc1
    s_mov_b32 s60, 1310720
    buffer_store_dwordx4 v[188:191], v227, s[36:39], s60 offen sc1
    s_waitcnt lgkmcnt(0)
    s_mov_b32 s60, 1310720
    buffer_store_dwordx4 v[192:195], v226, s[36:39], s60 offen sc1
    s_mov_b32 s60, 1966080
    buffer_store_dwordx4 v[196:199], v226, s[36:39], s60 offen sc1
    s_mov_b32 s60, 655360
    buffer_store_dwordx4 v[200:203], v227, s[36:39], s60 offen sc1
    s_mov_b32 s60, 0
    buffer_store_dwordx4 v[204:207], v227, s[36:39], s60 offen sc1
    s_endpgm
L_Acomp:
    s_mul_i32 s60, s70, 86
    s_lshr_b32 s60, s60, 8
    s_and_b32 s62, s50, 1
    s_lshl_b32 s62, s62, 3
    s_add_u32 s53, s62, s60
    s_and_b32 s60, s53, 7
    s_mul_i32 s61, s60, 3
    s_sub_u32 s67, s70, s61
    s_lshr_b32 s62, s50, 2
    s_mul_i32 s62, s62, 3
    s_add_u32 s56, s62, s67
    s_bfe_u32 s54, s2, 0x10001
    s_mul_i32 s60, s56, 352
    s_sub_u32 s60, s60, 32
    s_add_u32 s55, s60, s54
    s_lshl_b32 s52, s56, 1
    s_add_u32 s52, s52, s54
    s_and_b32 s60, s53, 7
    s_add_u32 s62, s60, 1
    s_mul_i32 s62, s62, 3
    s_lshr_b32 s62, s62, 3
    s_mul_i32 s62, s62, 3
    s_add_u32 s62, s62, s67
    s_bitcmp1_b32 0xa5, s60
    s_cselect_b32 s71, s62, 99
    s_cmp_ge_u32 s71, 12
    s_cbranch_scc1 L_pfb_skip
    s_lshl_b32 s60, s71, 2
    s_add_u32 s60, s60, s49
    s_lshl_b32 s60, s60, 5
    s_mov_b32 s61, 2
    s_cmp_lt_u32 s60, 960
    s_cbranch_scc0 L_pfb_x
    v_add_u32 v1, s60, v0
    v_mul_u32_u24 v3, 4370, v1
    v_lshrrev_b32 v3, 16, v3
    v_mul_u32_u24 v4, 15, v3
    v_sub_u32 v4, v1, v4
    v_mul_u32_u24 v2, 52, v4
    v_lshrrev_b32 v2, 8, v2
    v_mul_u32_u24 v2, 640, v2
    v_lshl_add_u32 v2, v4, 7, v2
    v_mul_u32_u24 v3, 3840, v3
    s_and_b32 s63, s50, 1
    s_mul_i32 s63, s63, 640
    v_add3_u32 v2, v2, v3, s63
    s_waitcnt lgkmcnt(0)
    s_mov_b32 s24, s6
    s_and_b32 s25, s7, 0xffff
    s_mov_b32 s26, 0x258000
    s_mov_b32 s27, 0x20000
    s_mul_i32 s63, s61, 245760
    s_mov_b32 exec_hi, 0
    buffer_load_dword v241, v2, s[24:27], s63 offen
    s_branch L_pfb_d
L_pfb_x:
    s_sub_u32 s60, s60, 960
    v_add_u32 v1, s60, v0
    s_and_b32 s63, s2, 4
    s_mulk_i32 s63, 124
    v_add_u32 v3, s63, v1
    s_bfe_u32 s63, s2, 0x10001
    v_lshl_add_u32 v3, v3, 1, s63
    v_mul_u32_u24 v2, 1280, v3
    v_cmp_lt_u32 vcc, 527, v1
    v_bfrev_b32 v4, 1
    s_nop 0
    v_cndmask_b32 v2, v2, v4, vcc
    s_waitcnt lgkmcnt(0)
    s_mov_b32 s20, s4
    s_and_b32 s21, s5, 0xffff
    s_mov_b32 s22, 0x280000
    s_mov_b32 s23, 0x20000
    s_lshl_b32 s63, s61, 7
    s_mov_b32 exec_hi, 0
    buffer_load_dword v241, v2, s[20:23], s63 offen
L_pfb_d:
    s_mov_b32 exec_hi, -1
L_pfb_skip:
    v_lshrrev_b32 v3, 4, v0
    v_bfe_u32 v4, v0, 2, 2
    v_and_b32 v5, 3, v0
    v_and_b32 v6, 1, v3
    v_lshl_add_u32 v6, v6, 2, v4
    v_lshlrev_b32 v6, 5, v6
    v_lshl_add_u32 v7, v3, 3, v4
    v_lshlrev_b32 v7, 8, v7
    v_mad_u32_u24 v8, v5, 8, v6
    v_add_u32 v8, 0, v8
    v_and_b32 v8, 255, v8
    v_add_u32 v10, v7, v8
    v_add_u32 v18, 118784, v10
    v_mad_u32_u24 v8, v5, 8, v6
    v_add_u32 v8, 40, v8
    v_and_b32 v8, 255, v8
    v_add_u32 v11, v7, v8
    v_add_u32 v19, 118784, v11
    v_mad_u32_u24 v8, v5, 8, v6
    v_add_u32 v8, 80, v8
    v_and_b32 v8, 255, v8
    v_add_u32 v12, v7, v8
    v_add_u32 v20, 118784, v12
    v_mad_u32_u24 v8, v5, 8, v6
    v_add_u32 v8, 120, v8
    v_and_b32 v8, 255, v8
    v_add_u32 v13, v7, v8
    v_add_u32 v21, 118784, v13
    v_mad_u32_u24 v8, v5, 40, v6
    v_add_u32 v8, 32, v8
    v_and_b32 v8, 255, v8
    v_add_u32 v14, v7, v8
    v_add_u32 v22, 118784, v14
    v_mad_u32_u24 v8, v5, 8, v6
    v_add_u32 v8, 160, v8
    v_and_b32 v8, 255, v8
    v_add_u32 v15, v7, v8
    v_add_u32 v23, 118784, v15
    v_mad_u32_u24 v8, v5, 8, v6
    v_add_u32 v8, 200, v8
    v_and_b32 v8, 255, v8
    v_add_u32 v16, v7, v8
    v_add_u32 v24, 118784, v16
    v_mul_u32_u24 v8, 40, v5
    v_lshlrev_b32 v9, 3, v5
    v_cmp_gt_u32 vcc, 2, v5
    s_nop 1
    v_cndmask_b32 v8, v9, v8, vcc
    v_add_u32 v8, v8, v6
    v_add_u32 v8, 192, v8
    v_and_b32 v8, 255, v8
    v_add_u32 v17, v7, v8
    v_add_u32 v25, 118784, v17
    v_and_b32 v4, 15, v0
    v_lshrrev_b32 v5, 1, v4
    v_xor_b32 v5, v5, v3
    v_lshlrev_b32 v5, 4, v5
    v_lshl_add_u32 v5, v4, 7, v5
    s_mul_i32 s60, s49, 6144
    s_add_u32 s60, s60, 32768
    v_add_u32 v26, s60, v5
    v_xor_b32 v27, 64, v26
    v_add_u32 v28, 102400, v26
    v_add_u32 v29, 102400, v27
    s_waitcnt lgkmcnt(0)
    s_mov_b32 s40, s14
    s_and_b32 s41, s15, 0xffff
    s_mov_b32 s42, 0x100
    s_mov_b32 s43, 0x20000
    s_mov_b32 s44, s16
    s_and_b32 s45, s17, 0xffff
    s_mov_b32 s46, 0x10000000
    s_mov_b32 s47, 0x20000
    v_mov_b32 v30, 0
    v_and_b32 v31, 15, v0
    v_lshlrev_b32 v31, 2, v31
    v_lshlrev_b32 v8, 2, v0
    v_add_u32 v8, 159744, v8
    ds_write_b32 v8, v30
    v_and_b32 v4, 15, v0
    v_lshlrev_b32 v5, 2, v3
    v_sub_u32 v5, v5, v4
    v_mov_b32 v6, 0xf149f2ca
    s_lshl_b32 s60, s56, 2
    s_or_b32 s60, s60, s49
    s_cmp_eq_u32 s60, 0
    s_cselect_b64 s[60:61], -1, 0
    v_add_u32 v7, 0, v5
    v_cmp_lt_i32 vcc, 8, v7
    s_nop 1
    v_cndmask_b32 v184, v6, v30, vcc
    v_add_u32 v7, 7, v7
    v_cmp_gt_u32 vcc, 8, v7
    s_nop 1
    v_cndmask_b32 v188, v6, v30, vcc
    v_cndmask_b32 v192, v184, v6, s[60:61]
    v_add_u32 v7, 1, v5
    v_cmp_lt_i32 vcc, 8, v7
    s_nop 1
    v_cndmask_b32 v185, v6, v30, vcc
    v_add_u32 v7, 7, v7
    v_cmp_gt_u32 vcc, 8, v7
    s_nop 1
    v_cndmask_b32 v189, v6, v30, vcc
    v_cndmask_b32 v193, v185, v6, s[60:61]
    v_add_u32 v7, 2, v5
    v_cmp_lt_i32 vcc, 8, v7
    s_nop 1
    v_cndmask_b32 v186, v6, v30, vcc
    v_add_u32 v7, 7, v7
    v_cmp_gt_u32 vcc, 8, v7
    s_nop 1
    v_cndmask_b32 v190, v6, v30, vcc
    v_cndmask_b32 v194, v186, v6, s[60:61]
    v_add_u32 v7, 3, v5
    v_cmp_lt_i32 vcc, 8, v7
    s_nop 1
    v_cndmask_b32 v187, v6, v30, vcc
    v_add_u32 v7, 7, v7
    v_cmp_gt_u32 vcc, 8, v7
    s_nop 1
    v_cndmask_b32 v191, v6, v30, vcc
    v_cndmask_b32 v195, v187, v6, s[60:61]
    v_cmp_eq_u32 vcc, 0, v184
    v_mov_b32 v7, 0xffff
    s_nop 0
    v_cndmask_b32 v7, v30, v7, vcc
    v_cmp_eq_u32 vcc, 0, v185
    v_mov_b32 v8, 0xffff0000
    s_nop 0
    v_cndmask_b32 v8, v30, v8, vcc
    v_or_b32 v196, v7, v8
    v_cmp_eq_u32 vcc, 0, v186
    v_mov_b32 v7, 0xffff
    s_nop 0
    v_cndmask_b32 v7, v30, v7, vcc
    v_cmp_eq_u32 vcc, 0, v187
    v_mov_b32 v8, 0xffff0000
    s_nop 0
    v_cndmask_b32 v8, v30, v8, vcc
    v_or_b32 v197, v7, v8
    v_mov_b32 v224, 0x3f803f80
    v_mov_b32 v225, 0x3f803f80
    v_mov_b32 v226, 0x3f803f80
    v_mov_b32 v227, 0x3f803f80
    s_mul_i32 s65, s56, 11
    s_mul_i32 s66, s49, 3
    s_add_u32 s65, s65, s66
    s_lshl_b32 s67, s54, 6
    s_add_u32 s67, s67, s65
    s_mul_i32 s67, s67, 20480
    s_lshl_b32 s66, s53, 10
    s_add_u32 s66, s66, s67
    s_lshl_b32 s68, s53, 8
    s_add_u32 s67, s67, s68
    s_add_u32 s67, s67, 16384
    v_lshlrev_b32 v198, 4, v0
    s_and_b32 s60, s53, 1
    v_xor_b32 v7, s60, v3
    v_lshlrev_b32 v7, 3, v7
    v_lshl_add_u32 v199, v4, 4, v7
    s_add_i32 s4, s66, -20480
    s_add_i32 s7, s67, -20480
    s_cmp_gt_u32 s65, 64
    s_cselect_b32 s4, 0x40000000, s4
    s_cselect_b32 s7, 0x40000000, s7
    s_add_i32 s5, s66, 0
    s_add_i32 s8, s67, 0
    s_cmp_gt_u32 s65, 63
    s_cselect_b32 s5, 0x40000000, s5
    s_cselect_b32 s8, 0x40000000, s8
    s_add_i32 s6, s66, 20480
    s_add_i32 s9, s67, 20480
    s_cmp_gt_u32 s65, 62
    s_cselect_b32 s6, 0x40000000, s6
    s_cselect_b32 s9, 0x40000000, s9
    s_cmp_eq_u32 s49, 0
    s_cselect_b32 s4, 0x40000000, s4
    s_cselect_b32 s7, 0x40000000, s7
    v_cmp_gt_u32 vcc, 32, v0
    v_bfrev_b32 v8, 1
    s_nop 0
    v_cndmask_b32 v199, v8, v199, vcc
    s_mul_i32 s58, s49, 3072
    s_add_u32 s59, s58, 102400
    v_lshl_add_u32 v8, v0, 3, s59
    s_sub_u32 s58, s58, 3072
    s_max_i32 s58, s58, 0
    s_add_u32 s58, s58, 102400
    v_lshl_add_u32 v1, v0, 3, s58
    s_lshl_b32 s57, s49, 2
    s_add_u32 s57, s57, 159744
    v_mov_b32 v31, s57
    v_mov_b32 v254, 1
    v_mov_b32 v255, 159744
    s_mov_b64 s[60:61], 0xffff
    s_mov_b32 s62, 0xffff0000
    s_mov_b32 s63, 0
    s_mov_b32 s64, 0x3ea52b5c
    s_mov_b32 s65, s64
    v_mov_b32 v238, 0
    v_mov_b32 v239, 0
    v_mov_b32 v244, 0
    v_mov_b32 v245, 0
    v_mov_b32 v250, 0
    v_mov_b32 v251, 0
    s_cmp_ge_u32 s71, 12
    s_cbranch_scc0 L_w47
    s_waitcnt vmcnt(0)
L_w47:
    s_waitcnt vmcnt(1) lgkmcnt(0)
    s_barrier
    ds_read_b128 v[160:163], v28 offset:0
    ds_read_b128 v[164:167], v28 offset:2048
    ds_read_b128 v[168:171], v28 offset:4096
    ds_read_b64_tr_b16 v[128:129], v18 offset:0
    ds_read_b64_tr_b16 v[130:131], v18 offset:1024
    ds_read_b64_tr_b16 v[132:133], v19 offset:0
    ds_read_b64_tr_b16 v[134:135], v19 offset:1024
    ds_read_b64_tr_b16 v[136:137], v20 offset:0
    ds_read_b64_tr_b16 v[138:139], v20 offset:1024
    ds_read_b64_tr_b16 v[140:141], v21 offset:0
    ds_read_b64_tr_b16 v[142:143], v21 offset:1024
    ds_read_b64_tr_b16 v[144:145], v22 offset:0
    ds_read_b64_tr_b16 v[146:147], v22 offset:1024
    ds_read_b64_tr_b16 v[148:149], v23 offset:0
    ds_read_b64_tr_b16 v[150:151], v23 offset:1024
    ds_read_b64_tr_b16 v[152:153], v24 offset:0
    ds_read_b64_tr_b16 v[154:155], v24 offset:1024
    ds_read_b64_tr_b16 v[156:157], v25 offset:0
    ds_read_b64_tr_b16 v[158:159], v25 offset:1024
    s_waitcnt lgkmcnt(14)
    v_mfma_f32_16x16x32_bf16 v[32:35], v[128:131], v[160:163], 0
    v_mfma_f32_16x16x32_bf16 v[36:39], v[128:131], v[164:167], 0
    v_mfma_f32_16x16x32_bf16 v[40:43], v[128:131], v[168:171], 0
    s_waitcnt lgkmcnt(12)
    v_mfma_f32_16x16x32_bf16 v[44:47], v[132:135], v[160:163], 0
    ds_read_b64_tr_b16 v[128:129], v18 offset:8192
    v_mfma_f32_16x16x32_bf16 v[48:51], v[132:135], v[164:167], 0
    ds_read_b64_tr_b16 v[130:131], v18 offset:9216
    v_mfma_f32_16x16x32_bf16 v[52:55], v[132:135], v[168:171], 0
    s_waitcnt lgkmcnt(12)
    v_mfma_f32_16x16x32_bf16 v[56:59], v[136:139], v[160:163], 0
    ds_read_b64_tr_b16 v[132:133], v19 offset:8192
    v_mfma_f32_16x16x32_bf16 v[60:63], v[136:139], v[164:167], 0
    ds_read_b64_tr_b16 v[134:135], v19 offset:9216
    v_mfma_f32_16x16x32_bf16 v[64:67], v[136:139], v[168:171], 0
    s_waitcnt lgkmcnt(12)
    v_mfma_f32_16x16x32_bf16 v[68:71], v[140:143], v[160:163], 0
    ds_read_b64_tr_b16 v[136:137], v20 offset:8192
    v_mfma_f32_16x16x32_bf16 v[72:75], v[140:143], v[164:167], 0
    ds_read_b64_tr_b16 v[138:139], v20 offset:9216
    v_mfma_f32_16x16x32_bf16 v[76:79], v[140:143], v[168:171], 0
    s_waitcnt lgkmcnt(12)
    v_mfma_f32_16x16x32_bf16 v[80:83], v[144:147], v[160:163], 0
    ds_read_b64_tr_b16 v[140:141], v21 offset:8192
    v_mfma_f32_16x16x32_bf16 v[84:87], v[144:147], v[164:167], 0
    ds_read_b64_tr_b16 v[142:143], v21 offset:9216
    v_mfma_f32_16x16x32_bf16 v[88:91], v[144:147], v[168:171], 0
    ds_read_b128 v[172:175], v29 offset:0
    s_waitcnt lgkmcnt(13)
    v_mfma_f32_16x16x32_bf16 v[92:95], v[160:163], v[148:151], 0
    ds_read_b64_tr_b16 v[144:145], v22 offset:8192
    v_mfma_f32_16x16x32_bf16 v[96:99], v[164:167], v[148:151], 0
    ds_read_b64_tr_b16 v[146:147], v22 offset:9216
    v_mfma_f32_16x16x32_bf16 v[100:103], v[168:171], v[148:151], 0
    ds_read_b128 v[176:179], v29 offset:2048
    s_waitcnt lgkmcnt(14)
    v_mfma_f32_16x16x32_bf16 v[104:107], v[160:163], v[152:155], 0
    ds_read_b64_tr_b16 v[148:149], v23 offset:8192
    v_mfma_f32_16x16x32_bf16 v[108:111], v[164:167], v[152:155], 0
    ds_read_b64_tr_b16 v[150:151], v23 offset:9216
    v_mfma_f32_16x16x32_bf16 v[112:115], v[168:171], v[152:155], 0
    ds_read_b128 v[180:183], v29 offset:4096
    s_waitcnt lgkmcnt(15)
    v_mfma_f32_16x16x32_bf16 v[116:119], v[160:163], v[156:159], 0
    ds_read_b64_tr_b16 v[152:153], v24 offset:8192
    v_mfma_f32_16x16x32_bf16 v[120:123], v[164:167], v[156:159], 0
    ds_read_b64_tr_b16 v[154:155], v24 offset:9216
    v_mfma_f32_16x16x32_bf16 v[124:127], v[168:171], v[156:159], 0
    s_waitcnt lgkmcnt(2)
    v_mfma_f32_16x16x32_bf16 v[32:35], v[128:131], v[172:175], v[32:35]
    ds_read_b64_tr_b16 v[156:157], v25 offset:8192
    v_mfma_f32_16x16x32_bf16 v[36:39], v[128:131], v[176:179], v[36:39]
    ds_read_b64_tr_b16 v[158:159], v25 offset:9216
    v_mfma_f32_16x16x32_bf16 v[40:43], v[128:131], v[180:183], v[40:43]
    v_mfma_f32_16x16x32_bf16 v[44:47], v[132:135], v[172:175], v[44:47]
    v_mfma_f32_16x16x32_bf16 v[48:51], v[132:135], v[176:179], v[48:51]
    v_mfma_f32_16x16x32_bf16 v[52:55], v[132:135], v[180:183], v[52:55]
    v_mfma_f32_16x16x32_bf16 v[56:59], v[136:139], v[172:175], v[56:59]
    v_mfma_f32_16x16x32_bf16 v[60:63], v[136:139], v[176:179], v[60:63]
    v_mfma_f32_16x16x32_bf16 v[64:67], v[136:139], v[180:183], v[64:67]
    s_waitcnt lgkmcnt(0)
    s_barrier
    v_mfma_f32_16x16x32_bf16 v[68:71], v[140:143], v[172:175], v[68:71]
    ds_read_b64_tr_b16 v[128:129], v10 offset:0
    ds_read_b64_tr_b16 v[130:131], v10 offset:1024
    v_mfma_f32_16x16x32_bf16 v[72:75], v[140:143], v[176:179], v[72:75]
    ds_read_b64_tr_b16 v[132:133], v11 offset:0
    ds_read_b64_tr_b16 v[134:135], v11 offset:1024
    v_mfma_f32_16x16x32_bf16 v[76:79], v[140:143], v[180:183], v[76:79]
    ds_read_b64_tr_b16 v[136:137], v12 offset:0
    ds_read_b64_tr_b16 v[138:139], v12 offset:1024
    v_mfma_f32_16x16x32_bf16 v[80:83], v[144:147], v[172:175], v[80:83]
    ds_read_b64_tr_b16 v[140:141], v13 offset:0
    v_mfma_f32_16x16x32_bf16 v[84:87], v[144:147], v[176:179], v[84:87]
    ds_read_b64_tr_b16 v[142:143], v13 offset:1024
    v_mfma_f32_16x16x32_bf16 v[88:91], v[144:147], v[180:183], v[88:91]
    ds_read_b128 v[160:163], v26 offset:0
    v_mfma_f32_16x16x32_bf16 v[92:95], v[172:175], v[148:151], v[92:95]
    ds_read_b64_tr_b16 v[144:145], v14 offset:0
    v_mfma_f32_16x16x32_bf16 v[96:99], v[176:179], v[148:151], v[96:99]
    ds_read_b64_tr_b16 v[146:147], v14 offset:1024
    v_mfma_f32_16x16x32_bf16 v[100:103], v[180:183], v[148:151], v[100:103]
    ds_read_b128 v[164:167], v26 offset:2048
    v_mfma_f32_16x16x32_bf16 v[104:107], v[172:175], v[152:155], v[104:107]
    ds_read_b64_tr_b16 v[148:149], v15 offset:0
    v_mfma_f32_16x16x32_bf16 v[108:111], v[176:179], v[152:155], v[108:111]
    ds_read_b64_tr_b16 v[150:151], v15 offset:1024
    v_mfma_f32_16x16x32_bf16 v[112:115], v[180:183], v[152:155], v[112:115]
    ds_read_b128 v[168:171], v26 offset:4096
    v_mfma_f32_16x16x32_bf16 v[116:119], v[172:175], v[156:159], v[116:119]
    ds_read_b64_tr_b16 v[152:153], v16 offset:0
    v_mfma_f32_16x16x32_bf16 v[120:123], v[176:179], v[156:159], v[120:123]
    ds_read_b64_tr_b16 v[154:155], v16 offset:1024
    v_mfma_f32_16x16x32_bf16 v[124:127], v[180:183], v[156:159], v[124:127]
    s_waitcnt lgkmcnt(2)
    v_mfma_f32_16x16x32_bf16 v[32:35], v[128:131], v[160:163], v[32:35]
    ds_read_b64_tr_b16 v[156:157], v17 offset:0
    v_mfma_f32_16x16x32_bf16 v[36:39], v[128:131], v[164:167], v[36:39]
    ds_read_b64_tr_b16 v[158:159], v17 offset:1024
    v_mfma_f32_16x16x32_bf16 v[40:43], v[128:131], v[168:171], v[40:43]
    v_mfma_f32_16x16x32_bf16 v[44:47], v[132:135], v[160:163], v[44:47]
    ds_read_b64_tr_b16 v[128:129], v10 offset:8192
    v_mfma_f32_16x16x32_bf16 v[48:51], v[132:135], v[164:167], v[48:51]
    ds_read_b64_tr_b16 v[130:131], v10 offset:9216
    v_mfma_f32_16x16x32_bf16 v[52:55], v[132:135], v[168:171], v[52:55]
    v_mfma_f32_16x16x32_bf16 v[56:59], v[136:139], v[160:163], v[56:59]
    ds_read_b64_tr_b16 v[132:133], v11 offset:8192
    v_mfma_f32_16x16x32_bf16 v[60:63], v[136:139], v[164:167], v[60:63]
    ds_read_b64_tr_b16 v[134:135], v11 offset:9216
    v_mfma_f32_16x16x32_bf16 v[64:67], v[136:139], v[168:171], v[64:67]
    v_mfma_f32_16x16x32_bf16 v[68:71], v[140:143], v[160:163], v[68:71]
    ds_read_b64_tr_b16 v[136:137], v12 offset:8192
    v_mfma_f32_16x16x32_bf16 v[72:75], v[140:143], v[164:167], v[72:75]
    ds_read_b64_tr_b16 v[138:139], v12 offset:9216
    v_mfma_f32_16x16x32_bf16 v[76:79], v[140:143], v[168:171], v[76:79]
    v_mfma_f32_16x16x32_bf16 v[80:83], v[144:147], v[160:163], v[80:83]
    ds_read_b64_tr_b16 v[140:141], v13 offset:8192
    v_mfma_f32_16x16x32_bf16 v[84:87], v[144:147], v[164:167], v[84:87]
    ds_read_b64_tr_b16 v[142:143], v13 offset:9216
    v_mfma_f32_16x16x32_bf16 v[88:91], v[144:147], v[168:171], v[88:91]
    ds_read_b128 v[172:175], v27 offset:0
    v_mfma_f32_16x16x32_bf16 v[92:95], v[160:163], v[148:151], v[92:95]
    ds_read_b64_tr_b16 v[144:145], v14 offset:8192
    v_mfma_f32_16x16x32_bf16 v[96:99], v[164:167], v[148:151], v[96:99]
    ds_read_b64_tr_b16 v[146:147], v14 offset:9216
    v_mfma_f32_16x16x32_bf16 v[100:103], v[168:171], v[148:151], v[100:103]
    ds_read_b128 v[176:179], v27 offset:2048
    s_waitcnt lgkmcnt(14)
    v_mfma_f32_16x16x32_bf16 v[104:107], v[160:163], v[152:155], v[104:107]
    ds_read_b64_tr_b16 v[148:149], v15 offset:8192
    v_mfma_f32_16x16x32_bf16 v[108:111], v[164:167], v[152:155], v[108:111]
    ds_read_b64_tr_b16 v[150:151], v15 offset:9216
    v_mfma_f32_16x16x32_bf16 v[112:115], v[168:171], v[152:155], v[112:115]
    ds_read_b128 v[180:183], v27 offset:4096
    s_waitcnt lgkmcnt(15)
    v_mfma_f32_16x16x32_bf16 v[116:119], v[160:163], v[156:159], v[116:119]
    ds_read_b64_tr_b16 v[152:153], v16 offset:8192
    v_mfma_f32_16x16x32_bf16 v[120:123], v[164:167], v[156:159], v[120:123]
    ds_read_b64_tr_b16 v[154:155], v16 offset:9216
    v_mfma_f32_16x16x32_bf16 v[124:127], v[168:171], v[156:159], v[124:127]
    s_waitcnt lgkmcnt(2)
    v_mfma_f32_16x16x32_bf16 v[32:35], v[128:131], v[172:175], v[32:35]
    ds_read_b64_tr_b16 v[156:157], v17 offset:8192
    v_mfma_f32_16x16x32_bf16 v[36:39], v[128:131], v[176:179], v[36:39]
    ds_read_b64_tr_b16 v[158:159], v17 offset:9216
    v_mfma_f32_16x16x32_bf16 v[40:43], v[128:131], v[180:183], v[40:43]
    v_mfma_f32_16x16x32_bf16 v[44:47], v[132:135], v[172:175], v[44:47]
    v_mfma_f32_16x16x32_bf16 v[48:51], v[132:135], v[176:179], v[48:51]
    v_mfma_f32_16x16x32_bf16 v[52:55], v[132:135], v[180:183], v[52:55]
    v_mfma_f32_16x16x32_bf16 v[56:59], v[136:139], v[172:175], v[56:59]
    v_mfma_f32_16x16x32_bf16 v[60:63], v[136:139], v[176:179], v[60:63]
    v_mfma_f32_16x16x32_bf16 v[64:67], v[136:139], v[180:183], v[64:67]
    s_waitcnt lgkmcnt(0)
    s_barrier
    v_mfma_f32_16x16x32_bf16 v[68:71], v[140:143], v[172:175], v[68:71]
    ds_read_b64_tr_b16 v[128:129], v10 offset:16384
    ds_read_b64_tr_b16 v[130:131], v10 offset:17408
    v_mfma_f32_16x16x32_bf16 v[72:75], v[140:143], v[176:179], v[72:75]
    ds_read_b64_tr_b16 v[132:133], v11 offset:16384
    ds_read_b64_tr_b16 v[134:135], v11 offset:17408
    v_mfma_f32_16x16x32_bf16 v[76:79], v[140:143], v[180:183], v[76:79]
    ds_read_b64_tr_b16 v[136:137], v12 offset:16384
    ds_read_b64_tr_b16 v[138:139], v12 offset:17408
    v_mfma_f32_16x16x32_bf16 v[80:83], v[144:147], v[172:175], v[80:83]
    ds_read_b64_tr_b16 v[140:141], v13 offset:16384
    v_mfma_f32_16x16x32_bf16 v[84:87], v[144:147], v[176:179], v[84:87]
    ds_read_b64_tr_b16 v[142:143], v13 offset:17408
    v_mfma_f32_16x16x32_bf16 v[88:91], v[144:147], v[180:183], v[88:91]
    ds_read_b128 v[160:163], v26 offset:24576
    v_mfma_f32_16x16x32_bf16 v[92:95], v[172:175], v[148:151], v[92:95]
    ds_read_b64_tr_b16 v[144:145], v14 offset:16384
    v_mfma_f32_16x16x32_bf16 v[96:99], v[176:179], v[148:151], v[96:99]
    ds_read_b64_tr_b16 v[146:147], v14 offset:17408
    v_mfma_f32_16x16x32_bf16 v[100:103], v[180:183], v[148:151], v[100:103]
    ds_read_b128 v[164:167], v26 offset:26624
    v_mfma_f32_16x16x32_bf16 v[104:107], v[172:175], v[152:155], v[104:107]
    ds_read_b64_tr_b16 v[148:149], v15 offset:16384
    v_mfma_f32_16x16x32_bf16 v[108:111], v[176:179], v[152:155], v[108:111]
    ds_read_b64_tr_b16 v[150:151], v15 offset:17408
    v_mfma_f32_16x16x32_bf16 v[112:115], v[180:183], v[152:155], v[112:115]
    ds_read_b128 v[168:171], v26 offset:28672
    v_mfma_f32_16x16x32_bf16 v[116:119], v[172:175], v[156:159], v[116:119]
    ds_read_b64_tr_b16 v[152:153], v16 offset:16384
    v_mfma_f32_16x16x32_bf16 v[120:123], v[176:179], v[156:159], v[120:123]
    ds_read_b64_tr_b16 v[154:155], v16 offset:17408
    v_mfma_f32_16x16x32_bf16 v[124:127], v[180:183], v[156:159], v[124:127]
    s_waitcnt lgkmcnt(2)
    v_mfma_f32_16x16x32_bf16 v[32:35], v[128:131], v[160:163], v[32:35]
    ds_read_b64_tr_b16 v[156:157], v17 offset:16384
    v_mfma_f32_16x16x32_bf16 v[36:39], v[128:131], v[164:167], v[36:39]
    ds_read_b64_tr_b16 v[158:159], v17 offset:17408
    v_mfma_f32_16x16x32_bf16 v[40:43], v[128:131], v[168:171], v[40:43]
    v_mfma_f32_16x16x32_bf16 v[44:47], v[132:135], v[160:163], v[44:47]
    ds_read_b64_tr_b16 v[128:129], v10 offset:24576
    v_mfma_f32_16x16x32_bf16 v[48:51], v[132:135], v[164:167], v[48:51]
    ds_read_b64_tr_b16 v[130:131], v10 offset:25600
    v_mfma_f32_16x16x32_bf16 v[52:55], v[132:135], v[168:171], v[52:55]
    v_mfma_f32_16x16x32_bf16 v[56:59], v[136:139], v[160:163], v[56:59]
    ds_read_b64_tr_b16 v[132:133], v11 offset:24576
    v_mfma_f32_16x16x32_bf16 v[60:63], v[136:139], v[164:167], v[60:63]
    ds_read_b64_tr_b16 v[134:135], v11 offset:25600
    v_mfma_f32_16x16x32_bf16 v[64:67], v[136:139], v[168:171], v[64:67]
    v_mfma_f32_16x16x32_bf16 v[68:71], v[140:143], v[160:163], v[68:71]
    ds_read_b64_tr_b16 v[136:137], v12 offset:24576
    v_mfma_f32_16x16x32_bf16 v[72:75], v[140:143], v[164:167], v[72:75]
    ds_read_b64_tr_b16 v[138:139], v12 offset:25600
    v_mfma_f32_16x16x32_bf16 v[76:79], v[140:143], v[168:171], v[76:79]
    v_mfma_f32_16x16x32_bf16 v[80:83], v[144:147], v[160:163], v[80:83]
    ds_read_b64_tr_b16 v[140:141], v13 offset:24576
    v_mfma_f32_16x16x32_bf16 v[84:87], v[144:147], v[164:167], v[84:87]
    ds_read_b64_tr_b16 v[142:143], v13 offset:25600
    v_mfma_f32_16x16x32_bf16 v[88:91], v[144:147], v[168:171], v[88:91]
    ds_read_b128 v[172:175], v27 offset:24576
    v_mfma_f32_16x16x32_bf16 v[92:95], v[160:163], v[148:151], v[92:95]
    ds_read_b64_tr_b16 v[144:145], v14 offset:24576
    v_mfma_f32_16x16x32_bf16 v[96:99], v[164:167], v[148:151], v[96:99]
    ds_read_b64_tr_b16 v[146:147], v14 offset:25600
    v_mfma_f32_16x16x32_bf16 v[100:103], v[168:171], v[148:151], v[100:103]
    ds_read_b128 v[176:179], v27 offset:26624
    s_waitcnt lgkmcnt(14)
    v_mfma_f32_16x16x32_bf16 v[104:107], v[160:163], v[152:155], v[104:107]
    ds_read_b64_tr_b16 v[148:149], v15 offset:24576
    v_mfma_f32_16x16x32_bf16 v[108:111], v[164:167], v[152:155], v[108:111]
    ds_read_b64_tr_b16 v[150:151], v15 offset:25600
    v_mfma_f32_16x16x32_bf16 v[112:115], v[168:171], v[152:155], v[112:115]
    ds_read_b128 v[180:183], v27 offset:28672
    s_waitcnt lgkmcnt(15)
    v_mfma_f32_16x16x32_bf16 v[116:119], v[160:163], v[156:159], v[116:119]
    ds_read_b64_tr_b16 v[152:153], v16 offset:24576
    v_mfma_f32_16x16x32_bf16 v[120:123], v[164:167], v[156:159], v[120:123]
    ds_read_b64_tr_b16 v[154:155], v16 offset:25600
    v_mfma_f32_16x16x32_bf16 v[124:127], v[168:171], v[156:159], v[124:127]
    s_waitcnt lgkmcnt(2)
    v_mfma_f32_16x16x32_bf16 v[32:35], v[128:131], v[172:175], v[32:35]
    ds_read_b64_tr_b16 v[156:157], v17 offset:24576
    v_mfma_f32_16x16x32_bf16 v[36:39], v[128:131], v[176:179], v[36:39]
    ds_read_b64_tr_b16 v[158:159], v17 offset:25600
    v_mfma_f32_16x16x32_bf16 v[40:43], v[128:131], v[180:183], v[40:43]
    v_mfma_f32_16x16x32_bf16 v[44:47], v[132:135], v[172:175], v[44:47]
    v_mfma_f32_16x16x32_bf16 v[48:51], v[132:135], v[176:179], v[48:51]
    v_mfma_f32_16x16x32_bf16 v[52:55], v[132:135], v[180:183], v[52:55]
    v_mfma_f32_16x16x32_bf16 v[56:59], v[136:139], v[172:175], v[56:59]
    v_mfma_f32_16x16x32_bf16 v[60:63], v[136:139], v[176:179], v[60:63]
    v_mfma_f32_16x16x32_bf16 v[64:67], v[136:139], v[180:183], v[64:67]
    s_waitcnt lgkmcnt(0)
    s_barrier
    v_mfma_f32_16x16x32_bf16 v[68:71], v[140:143], v[172:175], v[68:71]
    ds_read_b64_tr_b16 v[128:129], v18 offset:0
    ds_read_b64_tr_b16 v[130:131], v18 offset:1024
    v_mfma_f32_16x16x32_bf16 v[72:75], v[140:143], v[176:179], v[72:75]
    ds_read_b64_tr_b16 v[132:133], v19 offset:0
    ds_read_b64_tr_b16 v[134:135], v19 offset:1024
    v_mfma_f32_16x16x32_bf16 v[76:79], v[140:143], v[180:183], v[76:79]
    ds_read_b64_tr_b16 v[136:137], v20 offset:0
    ds_read_b64_tr_b16 v[138:139], v20 offset:1024
    v_mfma_f32_16x16x32_bf16 v[80:83], v[144:147], v[172:175], v[80:83]
    ds_read_b64_tr_b16 v[140:141], v21 offset:0
    v_mfma_f32_16x16x32_bf16 v[84:87], v[144:147], v[176:179], v[84:87]
    ds_read_b64_tr_b16 v[142:143], v21 offset:1024
    v_mfma_f32_16x16x32_bf16 v[88:91], v[144:147], v[180:183], v[88:91]
    ds_read_b128 v[160:163], v28 offset:0
    v_mfma_f32_16x16x32_bf16 v[92:95], v[172:175], v[148:151], v[92:95]
    ds_read_b64_tr_b16 v[144:145], v22 offset:0
    v_mfma_f32_16x16x32_bf16 v[96:99], v[176:179], v[148:151], v[96:99]
    ds_read_b64_tr_b16 v[146:147], v22 offset:1024
    v_mfma_f32_16x16x32_bf16 v[100:103], v[180:183], v[148:151], v[100:103]
    ds_read_b128 v[164:167], v28 offset:2048
    v_mfma_f32_16x16x32_bf16 v[104:107], v[172:175], v[152:155], v[104:107]
    ds_read_b64_tr_b16 v[148:149], v23 offset:0
    v_mfma_f32_16x16x32_bf16 v[108:111], v[176:179], v[152:155], v[108:111]
    ds_read_b64_tr_b16 v[150:151], v23 offset:1024
    v_mfma_f32_16x16x32_bf16 v[112:115], v[180:183], v[152:155], v[112:115]
    ds_read_b128 v[168:171], v28 offset:4096
    v_mfma_f32_16x16x32_bf16 v[116:119], v[172:175], v[156:159], v[116:119]
    ds_read_b64_tr_b16 v[152:153], v24 offset:0
    v_mfma_f32_16x16x32_bf16 v[120:123], v[176:179], v[156:159], v[120:123]
    ds_read_b64_tr_b16 v[154:155], v24 offset:1024
    v_mfma_f32_16x16x32_bf16 v[124:127], v[180:183], v[156:159], v[124:127]
    s_waitcnt lgkmcnt(2)
    v_mfma_f32_16x16x32_bf16 v[32:35], v[128:131], v[160:163], v[32:35]
    ds_read_b64_tr_b16 v[156:157], v25 offset:0
    v_mfma_f32_16x16x32_bf16 v[36:39], v[128:131], v[164:167], v[36:39]
    ds_read_b64_tr_b16 v[158:159], v25 offset:1024
    v_mfma_f32_16x16x32_bf16 v[40:43], v[128:131], v[168:171], v[40:43]
    v_mfma_f32_16x16x32_bf16 v[44:47], v[132:135], v[160:163], v[44:47]
    ds_read_b64_tr_b16 v[128:129], v18 offset:8192
    v_mfma_f32_16x16x32_bf16 v[48:51], v[132:135], v[164:167], v[48:51]
    ds_read_b64_tr_b16 v[130:131], v18 offset:9216
    v_mfma_f32_16x16x32_bf16 v[52:55], v[132:135], v[168:171], v[52:55]
    v_mfma_f32_16x16x32_bf16 v[56:59], v[136:139], v[160:163], v[56:59]
    ds_read_b64_tr_b16 v[132:133], v19 offset:8192
    v_mfma_f32_16x16x32_bf16 v[60:63], v[136:139], v[164:167], v[60:63]
    ds_read_b64_tr_b16 v[134:135], v19 offset:9216
    v_mfma_f32_16x16x32_bf16 v[64:67], v[136:139], v[168:171], v[64:67]
    v_mfma_f32_16x16x32_bf16 v[68:71], v[140:143], v[160:163], v[68:71]
    ds_read_b64_tr_b16 v[136:137], v20 offset:8192
    v_mfma_f32_16x16x32_bf16 v[72:75], v[140:143], v[164:167], v[72:75]
    ds_read_b64_tr_b16 v[138:139], v20 offset:9216
    v_mfma_f32_16x16x32_bf16 v[76:79], v[140:143], v[168:171], v[76:79]
    v_mfma_f32_16x16x32_bf16 v[80:83], v[144:147], v[160:163], v[80:83]
    ds_read_b64_tr_b16 v[140:141], v21 offset:8192
    v_mfma_f32_16x16x32_bf16 v[84:87], v[144:147], v[164:167], v[84:87]
    ds_read_b64_tr_b16 v[142:143], v21 offset:9216
    v_mfma_f32_16x16x32_bf16 v[88:91], v[144:147], v[168:171], v[88:91]
    ds_read_b128 v[172:175], v29 offset:0
    v_mfma_f32_16x16x32_bf16 v[92:95], v[160:163], v[148:151], v[92:95]
    ds_read_b64_tr_b16 v[144:145], v22 offset:8192
    v_mfma_f32_16x16x32_bf16 v[96:99], v[164:167], v[148:151], v[96:99]
    ds_read_b64_tr_b16 v[146:147], v22 offset:9216
    v_mfma_f32_16x16x32_bf16 v[100:103], v[168:171], v[148:151], v[100:103]
    ds_read_b128 v[176:179], v29 offset:2048
    s_waitcnt lgkmcnt(14)
    v_mfma_f32_16x16x32_bf16 v[104:107], v[160:163], v[152:155], v[104:107]
    ds_read_b64_tr_b16 v[148:149], v23 offset:8192
    v_mfma_f32_16x16x32_bf16 v[108:111], v[164:167], v[152:155], v[108:111]
    ds_read_b64_tr_b16 v[150:151], v23 offset:9216
    v_mfma_f32_16x16x32_bf16 v[112:115], v[168:171], v[152:155], v[112:115]
    ds_read_b128 v[180:183], v29 offset:4096
    s_waitcnt lgkmcnt(15)
    v_mfma_f32_16x16x32_bf16 v[116:119], v[160:163], v[156:159], v[116:119]
    ds_read_b64_tr_b16 v[152:153], v24 offset:8192
    v_mfma_f32_16x16x32_bf16 v[120:123], v[164:167], v[156:159], v[120:123]
    ds_read_b64_tr_b16 v[154:155], v24 offset:9216
    v_mfma_f32_16x16x32_bf16 v[124:127], v[168:171], v[156:159], v[124:127]
    s_waitcnt lgkmcnt(2)
    v_mfma_f32_16x16x32_bf16 v[32:35], v[128:131], v[172:175], v[32:35]
    ds_read_b64_tr_b16 v[156:157], v25 offset:8192
    v_mfma_f32_16x16x32_bf16 v[36:39], v[128:131], v[176:179], v[36:39]
    ds_read_b64_tr_b16 v[158:159], v25 offset:9216
    v_mfma_f32_16x16x32_bf16 v[40:43], v[128:131], v[180:183], v[40:43]
    v_mfma_f32_16x16x32_bf16 v[44:47], v[132:135], v[172:175], v[44:47]
    v_mfma_f32_16x16x32_bf16 v[48:51], v[132:135], v[176:179], v[48:51]
    v_mfma_f32_16x16x32_bf16 v[52:55], v[132:135], v[180:183], v[52:55]
    v_mfma_f32_16x16x32_bf16 v[56:59], v[136:139], v[172:175], v[56:59]
    v_mfma_f32_16x16x32_bf16 v[60:63], v[136:139], v[176:179], v[60:63]
    v_mfma_f32_16x16x32_bf16 v[64:67], v[136:139], v[180:183], v[64:67]
    s_waitcnt lgkmcnt(0)
    s_barrier
    v_mfma_f32_16x16x32_bf16 v[68:71], v[140:143], v[172:175], v[68:71]
    ds_read_b64_tr_b16 v[128:129], v10 offset:0
    ds_read_b64_tr_b16 v[130:131], v10 offset:1024
    v_mfma_f32_16x16x32_bf16 v[72:75], v[140:143], v[176:179], v[72:75]
    ds_read_b64_tr_b16 v[132:133], v11 offset:0
    ds_read_b64_tr_b16 v[134:135], v11 offset:1024
    v_mfma_f32_16x16x32_bf16 v[76:79], v[140:143], v[180:183], v[76:79]
    ds_read_b64_tr_b16 v[136:137], v12 offset:0
    ds_read_b64_tr_b16 v[138:139], v12 offset:1024
    v_mfma_f32_16x16x32_bf16 v[80:83], v[144:147], v[172:175], v[80:83]
    ds_read_b64_tr_b16 v[140:141], v13 offset:0
    v_mfma_f32_16x16x32_bf16 v[84:87], v[144:147], v[176:179], v[84:87]
    ds_read_b64_tr_b16 v[142:143], v13 offset:1024
    v_mfma_f32_16x16x32_bf16 v[88:91], v[144:147], v[180:183], v[88:91]
    ds_read_b128 v[160:163], v26 offset:0
    v_mfma_f32_16x16x32_bf16 v[92:95], v[172:175], v[148:151], v[92:95]
    ds_read_b64_tr_b16 v[144:145], v14 offset:0
    v_mfma_f32_16x16x32_bf16 v[96:99], v[176:179], v[148:151], v[96:99]
    ds_read_b64_tr_b16 v[146:147], v14 offset:1024
    v_mfma_f32_16x16x32_bf16 v[100:103], v[180:183], v[148:151], v[100:103]
    ds_read_b128 v[164:167], v26 offset:2048
    v_mfma_f32_16x16x32_bf16 v[104:107], v[172:175], v[152:155], v[104:107]
    ds_read_b64_tr_b16 v[148:149], v15 offset:0
    v_mfma_f32_16x16x32_bf16 v[108:111], v[176:179], v[152:155], v[108:111]
    ds_read_b64_tr_b16 v[150:151], v15 offset:1024
    v_mfma_f32_16x16x32_bf16 v[112:115], v[180:183], v[152:155], v[112:115]
    ds_read_b128 v[168:171], v26 offset:4096
    v_mfma_f32_16x16x32_bf16 v[116:119], v[172:175], v[156:159], v[116:119]
    ds_read_b64_tr_b16 v[152:153], v16 offset:0
    v_mfma_f32_16x16x32_bf16 v[120:123], v[176:179], v[156:159], v[120:123]
    ds_read_b64_tr_b16 v[154:155], v16 offset:1024
    v_mfma_f32_16x16x32_bf16 v[124:127], v[180:183], v[156:159], v[124:127]
    s_waitcnt lgkmcnt(2)
    v_mfma_f32_16x16x32_bf16 v[32:35], v[128:131], v[160:163], v[32:35]
    ds_read_b64_tr_b16 v[156:157], v17 offset:0
    v_mfma_f32_16x16x32_bf16 v[36:39], v[128:131], v[164:167], v[36:39]
    ds_read_b64_tr_b16 v[158:159], v17 offset:1024
    v_mfma_f32_16x16x32_bf16 v[40:43], v[128:131], v[168:171], v[40:43]
    v_mfma_f32_16x16x32_bf16 v[44:47], v[132:135], v[160:163], v[44:47]
    ds_read_b64_tr_b16 v[128:129], v10 offset:8192
    v_mfma_f32_16x16x32_bf16 v[48:51], v[132:135], v[164:167], v[48:51]
    ds_read_b64_tr_b16 v[130:131], v10 offset:9216
    v_mfma_f32_16x16x32_bf16 v[52:55], v[132:135], v[168:171], v[52:55]
    v_mfma_f32_16x16x32_bf16 v[56:59], v[136:139], v[160:163], v[56:59]
    ds_read_b64_tr_b16 v[132:133], v11 offset:8192
    v_mfma_f32_16x16x32_bf16 v[60:63], v[136:139], v[164:167], v[60:63]
    ds_read_b64_tr_b16 v[134:135], v11 offset:9216
    v_mfma_f32_16x16x32_bf16 v[64:67], v[136:139], v[168:171], v[64:67]
    v_mfma_f32_16x16x32_bf16 v[68:71], v[140:143], v[160:163], v[68:71]
    ds_read_b64_tr_b16 v[136:137], v12 offset:8192
    v_mfma_f32_16x16x32_bf16 v[72:75], v[140:143], v[164:167], v[72:75]
    ds_read_b64_tr_b16 v[138:139], v12 offset:9216
    v_mfma_f32_16x16x32_bf16 v[76:79], v[140:143], v[168:171], v[76:79]
    v_mfma_f32_16x16x32_bf16 v[80:83], v[144:147], v[160:163], v[80:83]
    ds_read_b64_tr_b16 v[140:141], v13 offset:8192
    v_mfma_f32_16x16x32_bf16 v[84:87], v[144:147], v[164:167], v[84:87]
    ds_read_b64_tr_b16 v[142:143], v13 offset:9216
    v_mfma_f32_16x16x32_bf16 v[88:91], v[144:147], v[168:171], v[88:91]
    ds_read_b128 v[172:175], v27 offset:0
    v_mfma_f32_16x16x32_bf16 v[92:95], v[160:163], v[148:151], v[92:95]
    ds_read_b64_tr_b16 v[144:145], v14 offset:8192
    v_mfma_f32_16x16x32_bf16 v[96:99], v[164:167], v[148:151], v[96:99]
    ds_read_b64_tr_b16 v[146:147], v14 offset:9216
    v_mfma_f32_16x16x32_bf16 v[100:103], v[168:171], v[148:151], v[100:103]
    ds_read_b128 v[176:179], v27 offset:2048
    s_waitcnt lgkmcnt(14)
    v_mfma_f32_16x16x32_bf16 v[104:107], v[160:163], v[152:155], v[104:107]
    ds_read_b64_tr_b16 v[148:149], v15 offset:8192
    v_mfma_f32_16x16x32_bf16 v[108:111], v[164:167], v[152:155], v[108:111]
    ds_read_b64_tr_b16 v[150:151], v15 offset:9216
    v_mfma_f32_16x16x32_bf16 v[112:115], v[168:171], v[152:155], v[112:115]
    ds_read_b128 v[180:183], v27 offset:4096
    s_waitcnt lgkmcnt(15)
    v_mfma_f32_16x16x32_bf16 v[116:119], v[160:163], v[156:159], v[116:119]
    ds_read_b64_tr_b16 v[152:153], v16 offset:8192
    v_mfma_f32_16x16x32_bf16 v[120:123], v[164:167], v[156:159], v[120:123]
    ds_read_b64_tr_b16 v[154:155], v16 offset:9216
    v_mfma_f32_16x16x32_bf16 v[124:127], v[168:171], v[156:159], v[124:127]
    s_waitcnt lgkmcnt(2)
    v_mfma_f32_16x16x32_bf16 v[32:35], v[128:131], v[172:175], v[32:35]
    ds_read_b64_tr_b16 v[156:157], v17 offset:8192
    v_mfma_f32_16x16x32_bf16 v[36:39], v[128:131], v[176:179], v[36:39]
    ds_read_b64_tr_b16 v[158:159], v17 offset:9216
    v_mfma_f32_16x16x32_bf16 v[40:43], v[128:131], v[180:183], v[40:43]
    v_mfma_f32_16x16x32_bf16 v[44:47], v[132:135], v[172:175], v[44:47]
    v_mfma_f32_16x16x32_bf16 v[48:51], v[132:135], v[176:179], v[48:51]
    v_mfma_f32_16x16x32_bf16 v[52:55], v[132:135], v[180:183], v[52:55]
    v_mfma_f32_16x16x32_bf16 v[56:59], v[136:139], v[172:175], v[56:59]
    v_mfma_f32_16x16x32_bf16 v[60:63], v[136:139], v[176:179], v[60:63]
    v_mfma_f32_16x16x32_bf16 v[64:67], v[136:139], v[180:183], v[64:67]
    s_waitcnt lgkmcnt(0)
    s_barrier
    v_mfma_f32_16x16x32_bf16 v[68:71], v[140:143], v[172:175], v[68:71]
    ds_read_b64_tr_b16 v[128:129], v10 offset:16384
    ds_read_b64_tr_b16 v[130:131], v10 offset:17408
    v_mfma_f32_16x16x32_bf16 v[72:75], v[140:143], v[176:179], v[72:75]
    ds_read_b64_tr_b16 v[132:133], v11 offset:16384
    ds_read_b64_tr_b16 v[134:135], v11 offset:17408
    v_mfma_f32_16x16x32_bf16 v[76:79], v[140:143], v[180:183], v[76:79]
    ds_read_b64_tr_b16 v[136:137], v12 offset:16384
    ds_read_b64_tr_b16 v[138:139], v12 offset:17408
    v_mfma_f32_16x16x32_bf16 v[80:83], v[144:147], v[172:175], v[80:83]
    ds_read_b64_tr_b16 v[140:141], v13 offset:16384
    v_mfma_f32_16x16x32_bf16 v[84:87], v[144:147], v[176:179], v[84:87]
    ds_read_b64_tr_b16 v[142:143], v13 offset:17408
    v_mfma_f32_16x16x32_bf16 v[88:91], v[144:147], v[180:183], v[88:91]
    ds_read_b128 v[160:163], v26 offset:24576
    v_mfma_f32_16x16x32_bf16 v[92:95], v[172:175], v[148:151], v[92:95]
    ds_read_b64_tr_b16 v[144:145], v14 offset:16384
    v_mfma_f32_16x16x32_bf16 v[96:99], v[176:179], v[148:151], v[96:99]
    ds_read_b64_tr_b16 v[146:147], v14 offset:17408
    v_mfma_f32_16x16x32_bf16 v[100:103], v[180:183], v[148:151], v[100:103]
    ds_read_b128 v[164:167], v26 offset:26624
    v_mfma_f32_16x16x32_bf16 v[104:107], v[172:175], v[152:155], v[104:107]
    ds_read_b64_tr_b16 v[148:149], v15 offset:16384
    v_mfma_f32_16x16x32_bf16 v[108:111], v[176:179], v[152:155], v[108:111]
    ds_read_b64_tr_b16 v[150:151], v15 offset:17408
    v_mfma_f32_16x16x32_bf16 v[112:115], v[180:183], v[152:155], v[112:115]
    ds_read_b128 v[168:171], v26 offset:28672
    v_mfma_f32_16x16x32_bf16 v[116:119], v[172:175], v[156:159], v[116:119]
    ds_read_b64_tr_b16 v[152:153], v16 offset:16384
    v_mfma_f32_16x16x32_bf16 v[120:123], v[176:179], v[156:159], v[120:123]
    ds_read_b64_tr_b16 v[154:155], v16 offset:17408
    v_mfma_f32_16x16x32_bf16 v[124:127], v[180:183], v[156:159], v[124:127]
    s_waitcnt lgkmcnt(2)
    v_mfma_f32_16x16x32_bf16 v[32:35], v[128:131], v[160:163], v[32:35]
    ds_read_b64_tr_b16 v[156:157], v17 offset:16384
    v_mfma_f32_16x16x32_bf16 v[36:39], v[128:131], v[164:167], v[36:39]
    ds_read_b64_tr_b16 v[158:159], v17 offset:17408
    v_mfma_f32_16x16x32_bf16 v[40:43], v[128:131], v[168:171], v[40:43]
    v_mfma_f32_16x16x32_bf16 v[44:47], v[132:135], v[160:163], v[44:47]
    ds_read_b64_tr_b16 v[128:129], v10 offset:24576
    v_mfma_f32_16x16x32_bf16 v[48:51], v[132:135], v[164:167], v[48:51]
    ds_read_b64_tr_b16 v[130:131], v10 offset:25600
    v_mfma_f32_16x16x32_bf16 v[52:55], v[132:135], v[168:171], v[52:55]
    v_mfma_f32_16x16x32_bf16 v[56:59], v[136:139], v[160:163], v[56:59]
    ds_read_b64_tr_b16 v[132:133], v11 offset:24576
    v_mfma_f32_16x16x32_bf16 v[60:63], v[136:139], v[164:167], v[60:63]
    ds_read_b64_tr_b16 v[134:135], v11 offset:25600
    v_mfma_f32_16x16x32_bf16 v[64:67], v[136:139], v[168:171], v[64:67]
    v_mfma_f32_16x16x32_bf16 v[68:71], v[140:143], v[160:163], v[68:71]
    ds_read_b64_tr_b16 v[136:137], v12 offset:24576
    v_mfma_f32_16x16x32_bf16 v[72:75], v[140:143], v[164:167], v[72:75]
    ds_read_b64_tr_b16 v[138:139], v12 offset:25600
    v_mfma_f32_16x16x32_bf16 v[76:79], v[140:143], v[168:171], v[76:79]
    v_mfma_f32_16x16x32_bf16 v[80:83], v[144:147], v[160:163], v[80:83]
    ds_read_b64_tr_b16 v[140:141], v13 offset:24576
    v_mfma_f32_16x16x32_bf16 v[84:87], v[144:147], v[164:167], v[84:87]
    ds_read_b64_tr_b16 v[142:143], v13 offset:25600
    v_mfma_f32_16x16x32_bf16 v[88:91], v[144:147], v[168:171], v[88:91]
    ds_read_b128 v[172:175], v27 offset:24576
    v_mfma_f32_16x16x32_bf16 v[92:95], v[160:163], v[148:151], v[92:95]
    ds_read_b64_tr_b16 v[144:145], v14 offset:24576
    v_mfma_f32_16x16x32_bf16 v[96:99], v[164:167], v[148:151], v[96:99]
    ds_read_b64_tr_b16 v[146:147], v14 offset:25600
    v_mfma_f32_16x16x32_bf16 v[100:103], v[168:171], v[148:151], v[100:103]
    ds_read_b128 v[176:179], v27 offset:26624
    s_waitcnt lgkmcnt(14)
    v_mfma_f32_16x16x32_bf16 v[104:107], v[160:163], v[152:155], v[104:107]
    ds_read_b64_tr_b16 v[148:149], v15 offset:24576
    v_mfma_f32_16x16x32_bf16 v[108:111], v[164:167], v[152:155], v[108:111]
    ds_read_b64_tr_b16 v[150:151], v15 offset:25600
    v_mfma_f32_16x16x32_bf16 v[112:115], v[168:171], v[152:155], v[112:115]
    ds_read_b128 v[180:183], v27 offset:28672
    s_waitcnt lgkmcnt(15)
    v_mfma_f32_16x16x32_bf16 v[116:119], v[160:163], v[156:159], v[116:119]
    ds_read_b64_tr_b16 v[152:153], v16 offset:24576
    v_mfma_f32_16x16x32_bf16 v[120:123], v[164:167], v[156:159], v[120:123]
    ds_read_b64_tr_b16 v[154:155], v16 offset:25600
    v_mfma_f32_16x16x32_bf16 v[124:127], v[168:171], v[156:159], v[124:127]
    s_waitcnt lgkmcnt(2)
    v_mfma_f32_16x16x32_bf16 v[32:35], v[128:131], v[172:175], v[32:35]
    ds_read_b64_tr_b16 v[156:157], v17 offset:24576
    v_mfma_f32_16x16x32_bf16 v[36:39], v[128:131], v[176:179], v[36:39]
    ds_read_b64_tr_b16 v[158:159], v17 offset:25600
    v_mfma_f32_16x16x32_bf16 v[40:43], v[128:131], v[180:183], v[40:43]
    v_mfma_f32_16x16x32_bf16 v[44:47], v[132:135], v[172:175], v[44:47]
    v_mfma_f32_16x16x32_bf16 v[48:51], v[132:135], v[176:179], v[48:51]
    v_mfma_f32_16x16x32_bf16 v[52:55], v[132:135], v[180:183], v[52:55]
    v_mfma_f32_16x16x32_bf16 v[56:59], v[136:139], v[172:175], v[56:59]
    v_mfma_f32_16x16x32_bf16 v[60:63], v[136:139], v[176:179], v[60:63]
    v_mfma_f32_16x16x32_bf16 v[64:67], v[136:139], v[180:183], v[64:67]
    s_waitcnt lgkmcnt(0)
    s_barrier
    v_mfma_f32_16x16x32_bf16 v[68:71], v[140:143], v[172:175], v[68:71]
    ds_read_b64_tr_b16 v[128:129], v18 offset:0
    ds_read_b64_tr_b16 v[130:131], v18 offset:1024
    v_mfma_f32_16x16x32_bf16 v[72:75], v[140:143], v[176:179], v[72:75]
    ds_read_b64_tr_b16 v[132:133], v19 offset:0
    ds_read_b64_tr_b16 v[134:135], v19 offset:1024
    v_mfma_f32_16x16x32_bf16 v[76:79], v[140:143], v[180:183], v[76:79]
    ds_read_b64_tr_b16 v[136:137], v20 offset:0
    ds_read_b64_tr_b16 v[138:139], v20 offset:1024
    v_mfma_f32_16x16x32_bf16 v[80:83], v[144:147], v[172:175], v[80:83]
    ds_read_b64_tr_b16 v[140:141], v21 offset:0
    v_mfma_f32_16x16x32_bf16 v[84:87], v[144:147], v[176:179], v[84:87]
    ds_read_b64_tr_b16 v[142:143], v21 offset:1024
    v_mfma_f32_16x16x32_bf16 v[88:91], v[144:147], v[180:183], v[88:91]
    ds_read_b128 v[160:163], v28 offset:0
    v_mfma_f32_16x16x32_bf16 v[92:95], v[172:175], v[148:151], v[92:95]
    ds_read_b64_tr_b16 v[144:145], v22 offset:0
    v_mfma_f32_16x16x32_bf16 v[96:99], v[176:179], v[148:151], v[96:99]
    ds_read_b64_tr_b16 v[146:147], v22 offset:1024
    v_mfma_f32_16x16x32_bf16 v[100:103], v[180:183], v[148:151], v[100:103]
    ds_read_b128 v[164:167], v28 offset:2048
    v_mfma_f32_16x16x32_bf16 v[104:107], v[172:175], v[152:155], v[104:107]
    ds_read_b64_tr_b16 v[148:149], v23 offset:0
    v_mfma_f32_16x16x32_bf16 v[108:111], v[176:179], v[152:155], v[108:111]
    ds_read_b64_tr_b16 v[150:151], v23 offset:1024
    v_mfma_f32_16x16x32_bf16 v[112:115], v[180:183], v[152:155], v[112:115]
    ds_read_b128 v[168:171], v28 offset:4096
    v_mfma_f32_16x16x32_bf16 v[116:119], v[172:175], v[156:159], v[116:119]
    ds_read_b64_tr_b16 v[152:153], v24 offset:0
    v_mfma_f32_16x16x32_bf16 v[120:123], v[176:179], v[156:159], v[120:123]
    ds_read_b64_tr_b16 v[154:155], v24 offset:1024
    v_mfma_f32_16x16x32_bf16 v[124:127], v[180:183], v[156:159], v[124:127]
    s_waitcnt lgkmcnt(2)
    v_mfma_f32_16x16x32_bf16 v[32:35], v[128:131], v[160:163], v[32:35]
    ds_read_b64_tr_b16 v[156:157], v25 offset:0
    v_mfma_f32_16x16x32_bf16 v[36:39], v[128:131], v[164:167], v[36:39]
    ds_read_b64_tr_b16 v[158:159], v25 offset:1024
    v_mfma_f32_16x16x32_bf16 v[40:43], v[128:131], v[168:171], v[40:43]
    v_mfma_f32_16x16x32_bf16 v[44:47], v[132:135], v[160:163], v[44:47]
    ds_read_b64_tr_b16 v[128:129], v18 offset:8192
    v_mfma_f32_16x16x32_bf16 v[48:51], v[132:135], v[164:167], v[48:51]
    ds_read_b64_tr_b16 v[130:131], v18 offset:9216
    v_mfma_f32_16x16x32_bf16 v[52:55], v[132:135], v[168:171], v[52:55]
    v_mfma_f32_16x16x32_bf16 v[56:59], v[136:139], v[160:163], v[56:59]
    ds_read_b64_tr_b16 v[132:133], v19 offset:8192
    v_mfma_f32_16x16x32_bf16 v[60:63], v[136:139], v[164:167], v[60:63]
    ds_read_b64_tr_b16 v[134:135], v19 offset:9216
    v_mfma_f32_16x16x32_bf16 v[64:67], v[136:139], v[168:171], v[64:67]
    v_mfma_f32_16x16x32_bf16 v[68:71], v[140:143], v[160:163], v[68:71]
    ds_read_b64_tr_b16 v[136:137], v20 offset:8192
    v_mfma_f32_16x16x32_bf16 v[72:75], v[140:143], v[164:167], v[72:75]
    ds_read_b64_tr_b16 v[138:139], v20 offset:9216
    v_mfma_f32_16x16x32_bf16 v[76:79], v[140:143], v[168:171], v[76:79]
    v_mfma_f32_16x16x32_bf16 v[80:83], v[144:147], v[160:163], v[80:83]
    ds_read_b64_tr_b16 v[140:141], v21 offset:8192
    v_mfma_f32_16x16x32_bf16 v[84:87], v[144:147], v[164:167], v[84:87]
    ds_read_b64_tr_b16 v[142:143], v21 offset:9216
    v_mfma_f32_16x16x32_bf16 v[88:91], v[144:147], v[168:171], v[88:91]
    ds_read_b128 v[172:175], v29 offset:0
    v_mfma_f32_16x16x32_bf16 v[92:95], v[160:163], v[148:151], v[92:95]
    ds_read_b64_tr_b16 v[144:145], v22 offset:8192
    v_mfma_f32_16x16x32_bf16 v[96:99], v[164:167], v[148:151], v[96:99]
    ds_read_b64_tr_b16 v[146:147], v22 offset:9216
    v_mfma_f32_16x16x32_bf16 v[100:103], v[168:171], v[148:151], v[100:103]
    ds_read_b128 v[176:179], v29 offset:2048
    s_waitcnt lgkmcnt(14)
    v_mfma_f32_16x16x32_bf16 v[104:107], v[160:163], v[152:155], v[104:107]
    ds_read_b64_tr_b16 v[148:149], v23 offset:8192
    v_mfma_f32_16x16x32_bf16 v[108:111], v[164:167], v[152:155], v[108:111]
    ds_read_b64_tr_b16 v[150:151], v23 offset:9216
    v_mfma_f32_16x16x32_bf16 v[112:115], v[168:171], v[152:155], v[112:115]
    ds_read_b128 v[180:183], v29 offset:4096
    s_waitcnt lgkmcnt(15)
    v_mfma_f32_16x16x32_bf16 v[116:119], v[160:163], v[156:159], v[116:119]
    ds_read_b64_tr_b16 v[152:153], v24 offset:8192
    v_mfma_f32_16x16x32_bf16 v[120:123], v[164:167], v[156:159], v[120:123]
    ds_read_b64_tr_b16 v[154:155], v24 offset:9216
    v_mfma_f32_16x16x32_bf16 v[124:127], v[168:171], v[156:159], v[124:127]
    s_waitcnt lgkmcnt(2)
    v_mfma_f32_16x16x32_bf16 v[32:35], v[128:131], v[172:175], v[32:35]
    ds_read_b64_tr_b16 v[156:157], v25 offset:8192
    v_mfma_f32_16x16x32_bf16 v[36:39], v[128:131], v[176:179], v[36:39]
    ds_read_b64_tr_b16 v[158:159], v25 offset:9216
    v_mfma_f32_16x16x32_bf16 v[40:43], v[128:131], v[180:183], v[40:43]
    v_mfma_f32_16x16x32_bf16 v[44:47], v[132:135], v[172:175], v[44:47]
    v_mfma_f32_16x16x32_bf16 v[48:51], v[132:135], v[176:179], v[48:51]
    v_mfma_f32_16x16x32_bf16 v[52:55], v[132:135], v[180:183], v[52:55]
    v_mfma_f32_16x16x32_bf16 v[56:59], v[136:139], v[172:175], v[56:59]
    v_mfma_f32_16x16x32_bf16 v[60:63], v[136:139], v[176:179], v[60:63]
    v_mfma_f32_16x16x32_bf16 v[64:67], v[136:139], v[180:183], v[64:67]
    s_waitcnt lgkmcnt(0)
    s_barrier
    buffer_load_dword v9, v30, s[40:43], 0 offen sc1
    v_mfma_f32_16x16x32_bf16 v[68:71], v[140:143], v[172:175], v[68:71]
    ds_read_b64_tr_b16 v[128:129], v10 offset:0
    ds_read_b64_tr_b16 v[130:131], v10 offset:1024
    v_mfma_f32_16x16x32_bf16 v[72:75], v[140:143], v[176:179], v[72:75]
    ds_read_b64_tr_b16 v[132:133], v11 offset:0
    ds_read_b64_tr_b16 v[134:135], v11 offset:1024
    v_mfma_f32_16x16x32_bf16 v[76:79], v[140:143], v[180:183], v[76:79]
    ds_read_b64_tr_b16 v[136:137], v12 offset:0
    ds_read_b64_tr_b16 v[138:139], v12 offset:1024
    v_mfma_f32_16x16x32_bf16 v[80:83], v[144:147], v[172:175], v[80:83]
    ds_read_b64_tr_b16 v[140:141], v13 offset:0
    v_mfma_f32_16x16x32_bf16 v[84:87], v[144:147], v[176:179], v[84:87]
    ds_read_b64_tr_b16 v[142:143], v13 offset:1024
    v_mfma_f32_16x16x32_bf16 v[88:91], v[144:147], v[180:183], v[88:91]
    ds_read_b128 v[160:163], v26 offset:0
    v_mfma_f32_16x16x32_bf16 v[92:95], v[172:175], v[148:151], v[92:95]
    ds_read_b64_tr_b16 v[144:145], v14 offset:0
    v_mfma_f32_16x16x32_bf16 v[96:99], v[176:179], v[148:151], v[96:99]
    ds_read_b64_tr_b16 v[146:147], v14 offset:1024
    v_mfma_f32_16x16x32_bf16 v[100:103], v[180:183], v[148:151], v[100:103]
    ds_read_b128 v[164:167], v26 offset:2048
    v_mfma_f32_16x16x32_bf16 v[104:107], v[172:175], v[152:155], v[104:107]
    ds_read_b64_tr_b16 v[148:149], v15 offset:0
    v_mfma_f32_16x16x32_bf16 v[108:111], v[176:179], v[152:155], v[108:111]
    ds_read_b64_tr_b16 v[150:151], v15 offset:1024
    v_mfma_f32_16x16x32_bf16 v[112:115], v[180:183], v[152:155], v[112:115]
    ds_read_b128 v[168:171], v26 offset:4096
    v_mfma_f32_16x16x32_bf16 v[116:119], v[172:175], v[156:159], v[116:119]
    ds_read_b64_tr_b16 v[152:153], v16 offset:0
    v_mfma_f32_16x16x32_bf16 v[120:123], v[176:179], v[156:159], v[120:123]
    ds_read_b64_tr_b16 v[154:155], v16 offset:1024
    v_mfma_f32_16x16x32_bf16 v[124:127], v[180:183], v[156:159], v[124:127]
    s_waitcnt lgkmcnt(2)
    v_mfma_f32_16x16x32_bf16 v[32:35], v[128:131], v[160:163], v[32:35]
    ds_read_b64_tr_b16 v[156:157], v17 offset:0
    v_mfma_f32_16x16x32_bf16 v[36:39], v[128:131], v[164:167], v[36:39]
    ds_read_b64_tr_b16 v[158:159], v17 offset:1024
    v_mfma_f32_16x16x32_bf16 v[40:43], v[128:131], v[168:171], v[40:43]
    v_mfma_f32_16x16x32_bf16 v[44:47], v[132:135], v[160:163], v[44:47]
    ds_read_b64_tr_b16 v[128:129], v10 offset:8192
    v_mfma_f32_16x16x32_bf16 v[48:51], v[132:135], v[164:167], v[48:51]
    ds_read_b64_tr_b16 v[130:131], v10 offset:9216
    v_mfma_f32_16x16x32_bf16 v[52:55], v[132:135], v[168:171], v[52:55]
    v_mfma_f32_16x16x32_bf16 v[56:59], v[136:139], v[160:163], v[56:59]
    ds_read_b64_tr_b16 v[132:133], v11 offset:8192
    v_mfma_f32_16x16x32_bf16 v[60:63], v[136:139], v[164:167], v[60:63]
    ds_read_b64_tr_b16 v[134:135], v11 offset:9216
    v_mfma_f32_16x16x32_bf16 v[64:67], v[136:139], v[168:171], v[64:67]
    v_mfma_f32_16x16x32_bf16 v[68:71], v[140:143], v[160:163], v[68:71]
    ds_read_b64_tr_b16 v[136:137], v12 offset:8192
    v_mfma_f32_16x16x32_bf16 v[72:75], v[140:143], v[164:167], v[72:75]
    ds_read_b64_tr_b16 v[138:139], v12 offset:9216
    v_mfma_f32_16x16x32_bf16 v[76:79], v[140:143], v[168:171], v[76:79]
    v_mfma_f32_16x16x32_bf16 v[80:83], v[144:147], v[160:163], v[80:83]
    ds_read_b64_tr_b16 v[140:141], v13 offset:8192
    v_mfma_f32_16x16x32_bf16 v[84:87], v[144:147], v[164:167], v[84:87]
    ds_read_b64_tr_b16 v[142:143], v13 offset:9216
    v_mfma_f32_16x16x32_bf16 v[88:91], v[144:147], v[168:171], v[88:91]
    ds_read_b128 v[172:175], v27 offset:0
    v_mfma_f32_16x16x32_bf16 v[92:95], v[160:163], v[148:151], v[92:95]
    ds_read_b64_tr_b16 v[144:145], v14 offset:8192
    v_mfma_f32_16x16x32_bf16 v[96:99], v[164:167], v[148:151], v[96:99]
    ds_read_b64_tr_b16 v[146:147], v14 offset:9216
    v_mfma_f32_16x16x32_bf16 v[100:103], v[168:171], v[148:151], v[100:103]
    ds_read_b128 v[176:179], v27 offset:2048
    s_waitcnt lgkmcnt(14)
    v_mfma_f32_16x16x32_bf16 v[104:107], v[160:163], v[152:155], v[104:107]
    ds_read_b64_tr_b16 v[148:149], v15 offset:8192
    v_mfma_f32_16x16x32_bf16 v[108:111], v[164:167], v[152:155], v[108:111]
    ds_read_b64_tr_b16 v[150:151], v15 offset:9216
    v_mfma_f32_16x16x32_bf16 v[112:115], v[168:171], v[152:155], v[112:115]
    ds_read_b128 v[180:183], v27 offset:4096
    s_waitcnt lgkmcnt(15)
    v_mfma_f32_16x16x32_bf16 v[116:119], v[160:163], v[156:159], v[116:119]
    ds_read_b64_tr_b16 v[152:153], v16 offset:8192
    v_mfma_f32_16x16x32_bf16 v[120:123], v[164:167], v[156:159], v[120:123]
    ds_read_b64_tr_b16 v[154:155], v16 offset:9216
    v_mfma_f32_16x16x32_bf16 v[124:127], v[168:171], v[156:159], v[124:127]
    s_waitcnt lgkmcnt(2)
    v_mfma_f32_16x16x32_bf16 v[32:35], v[128:131], v[172:175], v[32:35]
    ds_read_b64_tr_b16 v[156:157], v17 offset:8192
    v_mfma_f32_16x16x32_bf16 v[36:39], v[128:131], v[176:179], v[36:39]
    ds_read_b64_tr_b16 v[158:159], v17 offset:9216
    v_mfma_f32_16x16x32_bf16 v[40:43], v[128:131], v[180:183], v[40:43]
    v_mfma_f32_16x16x32_bf16 v[44:47], v[132:135], v[172:175], v[44:47]
    v_mfma_f32_16x16x32_bf16 v[48:51], v[132:135], v[176:179], v[48:51]
    v_mfma_f32_16x16x32_bf16 v[52:55], v[132:135], v[180:183], v[52:55]
    v_mfma_f32_16x16x32_bf16 v[56:59], v[136:139], v[172:175], v[56:59]
    v_mfma_f32_16x16x32_bf16 v[60:63], v[136:139], v[176:179], v[60:63]
    v_mfma_f32_16x16x32_bf16 v[64:67], v[136:139], v[180:183], v[64:67]
    s_waitcnt lgkmcnt(0)
    s_barrier
    v_mfma_f32_16x16x32_bf16 v[68:71], v[140:143], v[172:175], v[68:71]
    ds_read_b64_tr_b16 v[128:129], v10 offset:16384
    ds_read_b64_tr_b16 v[130:131], v10 offset:17408
    v_mfma_f32_16x16x32_bf16 v[72:75], v[140:143], v[176:179], v[72:75]
    ds_read_b64_tr_b16 v[132:133], v11 offset:16384
    ds_read_b64_tr_b16 v[134:135], v11 offset:17408
    v_mfma_f32_16x16x32_bf16 v[76:79], v[140:143], v[180:183], v[76:79]
    ds_read_b64_tr_b16 v[136:137], v12 offset:16384
    ds_read_b64_tr_b16 v[138:139], v12 offset:17408
    v_mfma_f32_16x16x32_bf16 v[80:83], v[144:147], v[172:175], v[80:83]
    ds_read_b64_tr_b16 v[140:141], v13 offset:16384
    v_mfma_f32_16x16x32_bf16 v[84:87], v[144:147], v[176:179], v[84:87]
    ds_read_b64_tr_b16 v[142:143], v13 offset:17408
    v_mfma_f32_16x16x32_bf16 v[88:91], v[144:147], v[180:183], v[88:91]
    ds_read_b128 v[160:163], v26 offset:24576
    v_mfma_f32_16x16x32_bf16 v[92:95], v[172:175], v[148:151], v[92:95]
    ds_read_b64_tr_b16 v[144:145], v14 offset:16384
    v_mfma_f32_16x16x32_bf16 v[96:99], v[176:179], v[148:151], v[96:99]
    ds_read_b64_tr_b16 v[146:147], v14 offset:17408
    v_mfma_f32_16x16x32_bf16 v[100:103], v[180:183], v[148:151], v[100:103]
    ds_read_b128 v[164:167], v26 offset:26624
    v_mfma_f32_16x16x32_bf16 v[104:107], v[172:175], v[152:155], v[104:107]
    ds_read_b64_tr_b16 v[148:149], v15 offset:16384
    v_mfma_f32_16x16x32_bf16 v[108:111], v[176:179], v[152:155], v[108:111]
    ds_read_b64_tr_b16 v[150:151], v15 offset:17408
    v_mfma_f32_16x16x32_bf16 v[112:115], v[180:183], v[152:155], v[112:115]
    ds_read_b128 v[168:171], v26 offset:28672
    v_mfma_f32_16x16x32_bf16 v[116:119], v[172:175], v[156:159], v[116:119]
    ds_read_b64_tr_b16 v[152:153], v16 offset:16384
    v_mfma_f32_16x16x32_bf16 v[120:123], v[176:179], v[156:159], v[120:123]
    ds_read_b64_tr_b16 v[154:155], v16 offset:17408
    v_mfma_f32_16x16x32_bf16 v[124:127], v[180:183], v[156:159], v[124:127]
    s_waitcnt lgkmcnt(2)
    v_mfma_f32_16x16x32_bf16 v[32:35], v[128:131], v[160:163], v[32:35]
    ds_read_b64_tr_b16 v[156:157], v17 offset:16384
    v_mfma_f32_16x16x32_bf16 v[36:39], v[128:131], v[164:167], v[36:39]
    ds_read_b64_tr_b16 v[158:159], v17 offset:17408
    v_mfma_f32_16x16x32_bf16 v[40:43], v[128:131], v[168:171], v[40:43]
    v_mfma_f32_16x16x32_bf16 v[44:47], v[132:135], v[160:163], v[44:47]
    ds_read_b64_tr_b16 v[128:129], v10 offset:24576
    v_mfma_f32_16x16x32_bf16 v[48:51], v[132:135], v[164:167], v[48:51]
    ds_read_b64_tr_b16 v[130:131], v10 offset:25600
    v_mfma_f32_16x16x32_bf16 v[52:55], v[132:135], v[168:171], v[52:55]
    v_mfma_f32_16x16x32_bf16 v[56:59], v[136:139], v[160:163], v[56:59]
    ds_read_b64_tr_b16 v[132:133], v11 offset:24576
    v_mfma_f32_16x16x32_bf16 v[60:63], v[136:139], v[164:167], v[60:63]
    ds_read_b64_tr_b16 v[134:135], v11 offset:25600
    v_mfma_f32_16x16x32_bf16 v[64:67], v[136:139], v[168:171], v[64:67]
    v_mfma_f32_16x16x32_bf16 v[68:71], v[140:143], v[160:163], v[68:71]
    ds_read_b64_tr_b16 v[136:137], v12 offset:24576
    v_mfma_f32_16x16x32_bf16 v[72:75], v[140:143], v[164:167], v[72:75]
    ds_read_b64_tr_b16 v[138:139], v12 offset:25600
    v_mfma_f32_16x16x32_bf16 v[76:79], v[140:143], v[168:171], v[76:79]
    v_mfma_f32_16x16x32_bf16 v[80:83], v[144:147], v[160:163], v[80:83]
    ds_read_b64_tr_b16 v[140:141], v13 offset:24576
    v_mfma_f32_16x16x32_bf16 v[84:87], v[144:147], v[164:167], v[84:87]
    ds_read_b64_tr_b16 v[142:143], v13 offset:25600
    v_mfma_f32_16x16x32_bf16 v[88:91], v[144:147], v[168:171], v[88:91]
    ds_read_b128 v[172:175], v27 offset:24576
    v_mfma_f32_16x16x32_bf16 v[92:95], v[160:163], v[148:151], v[92:95]
    ds_read_b64_tr_b16 v[144:145], v14 offset:24576
    v_mfma_f32_16x16x32_bf16 v[96:99], v[164:167], v[148:151], v[96:99]
    ds_read_b64_tr_b16 v[146:147], v14 offset:25600
    v_mfma_f32_16x16x32_bf16 v[100:103], v[168:171], v[148:151], v[100:103]
    ds_read_b128 v[176:179], v27 offset:26624
    s_waitcnt lgkmcnt(14)
    v_mfma_f32_16x16x32_bf16 v[104:107], v[160:163], v[152:155], v[104:107]
    ds_read_b64_tr_b16 v[148:149], v15 offset:24576
    v_mfma_f32_16x16x32_bf16 v[108:111], v[164:167], v[152:155], v[108:111]
    ds_read_b64_tr_b16 v[150:151], v15 offset:25600
    v_mfma_f32_16x16x32_bf16 v[112:115], v[168:171], v[152:155], v[112:115]
    ds_read_b128 v[180:183], v27 offset:28672
    s_waitcnt lgkmcnt(15)
    v_mfma_f32_16x16x32_bf16 v[116:119], v[160:163], v[156:159], v[116:119]
    ds_read_b64_tr_b16 v[152:153], v16 offset:24576
    v_mfma_f32_16x16x32_bf16 v[120:123], v[164:167], v[156:159], v[120:123]
    ds_read_b64_tr_b16 v[154:155], v16 offset:25600
    v_mfma_f32_16x16x32_bf16 v[124:127], v[168:171], v[156:159], v[124:127]
    s_waitcnt lgkmcnt(2)
    v_mfma_f32_16x16x32_bf16 v[32:35], v[128:131], v[172:175], v[32:35]
    ds_read_b64_tr_b16 v[156:157], v17 offset:24576
    v_mfma_f32_16x16x32_bf16 v[36:39], v[128:131], v[176:179], v[36:39]
    ds_read_b64_tr_b16 v[158:159], v17 offset:25600
    v_mfma_f32_16x16x32_bf16 v[40:43], v[128:131], v[180:183], v[40:43]
    v_mfma_f32_16x16x32_bf16 v[44:47], v[132:135], v[172:175], v[44:47]
    v_mfma_f32_16x16x32_bf16 v[48:51], v[132:135], v[176:179], v[48:51]
    v_mfma_f32_16x16x32_bf16 v[52:55], v[132:135], v[180:183], v[52:55]
    v_mfma_f32_16x16x32_bf16 v[56:59], v[136:139], v[172:175], v[56:59]
    v_mfma_f32_16x16x32_bf16 v[60:63], v[136:139], v[176:179], v[60:63]
    v_mfma_f32_16x16x32_bf16 v[64:67], v[136:139], v[180:183], v[64:67]
    s_waitcnt vmcnt(0)
    s_mov_b32 s69, 0
L_dbg_37:
    v_cmp_ne_u32 vcc, 1, v9
    s_cbranch_vccz L_dbgok_38
    s_add_u32 s69, s69, 1
    s_cmp_gt_u32 s69, 1048576
    s_cbranch_scc1 L_dbgok_38
    buffer_load_dword v9, v30, s[40:43], 0 offen sc1
    s_waitcnt vmcnt(0)
    s_branch L_dbg_37
L_dbgok_38:
    s_waitcnt lgkmcnt(0)
    s_barrier
    v_mfma_f32_16x16x32_bf16 v[68:71], v[140:143], v[172:175], v[68:71]
    ds_read_b128 v[168:171], v28 offset:4096
    ds_read_b128 v[164:167], v28 offset:2048
    v_mfma_f32_16x16x32_bf16 v[72:75], v[140:143], v[176:179], v[72:75]
    ds_read_b128 v[160:163], v28 offset:0
    ds_read_b64_tr_b16 v[128:129], v20 offset:0
    v_mfma_f32_16x16x32_bf16 v[76:79], v[140:143], v[180:183], v[76:79]
    ds_read_b64_tr_b16 v[130:131], v20 offset:1024
    ds_read_b64_tr_b16 v[136:137], v22 offset:0
    v_mfma_f32_16x16x32_bf16 v[80:83], v[144:147], v[172:175], v[80:83]
    ds_read_b64_tr_b16 v[138:139], v22 offset:1024
    ds_read_b64_tr_b16 v[132:133], v21 offset:0
    v_mfma_f32_16x16x32_bf16 v[84:87], v[144:147], v[176:179], v[84:87]
    ds_read_b64_tr_b16 v[134:135], v21 offset:1024
    ds_read_b64_tr_b16 v[140:141], v20 offset:8192
    v_mfma_f32_16x16x32_bf16 v[88:91], v[144:147], v[180:183], v[88:91]
    ds_read_b64_tr_b16 v[142:143], v20 offset:9216
    ds_read_b64_tr_b16 v[144:145], v21 offset:8192
    v_mfma_f32_16x16x32_bf16 v[92:95], v[172:175], v[148:151], v[92:95]
    ds_read_b64_tr_b16 v[146:147], v21 offset:9216
    v_add_u32 v16, s6, v198
    v_mfma_f32_16x16x32_bf16 v[96:99], v[176:179], v[148:151], v[96:99]
    v_add_u32 v17, s9, v199
    v_add_u32 v26, s5, v198
    v_mfma_f32_16x16x32_bf16 v[100:103], v[180:183], v[148:151], v[100:103]
    ds_read_b64_tr_b16 v[148:149], v22 offset:8192
    ds_read_b64_tr_b16 v[150:151], v22 offset:9216
    v_mfma_f32_16x16x32_bf16 v[104:107], v[172:175], v[152:155], v[104:107]
    v_add_u32 v27, s8, v199
    v_add_u32 v198, s4, v198
    v_mfma_f32_16x16x32_bf16 v[108:111], v[176:179], v[152:155], v[108:111]
    v_add_u32 v199, s7, v199
    v_mfma_f32_16x16x32_bf16 v[112:115], v[180:183], v[152:155], v[112:115]
    ds_read_b64_tr_b16 v[152:153], v23 offset:0
    ds_read_b64_tr_b16 v[154:155], v23 offset:1024
    v_mfma_f32_16x16x32_bf16 v[116:119], v[172:175], v[156:159], v[116:119]
    ds_read_b128 v[172:175], v29 offset:0
    v_mfma_f32_16x16x32_bf16 v[120:123], v[176:179], v[156:159], v[120:123]
    ds_read_b128 v[176:179], v29 offset:2048
    v_mfma_f32_16x16x32_bf16 v[124:127], v[180:183], v[156:159], v[124:127]
    ds_read_b128 v[180:183], v29 offset:4096
    ds_read_b64_tr_b16 v[156:157], v23 offset:8192
    s_waitcnt lgkmcnt(15)
    v_mfma_f32_16x16x32_bf16 v[64:67], v[128:131], v[168:171], v[64:67]
    ds_read_b64_tr_b16 v[158:159], v23 offset:9216
    v_mfma_f32_16x16x32_bf16 v[60:63], v[128:131], v[164:167], v[60:63]
    v_mfma_f32_16x16x32_bf16 v[56:59], v[128:131], v[160:163], v[56:59]
    ds_read_b64_tr_b16 v[128:129], v24 offset:0
    ds_read_b64_tr_b16 v[130:131], v24 offset:1024
    s_waitcnt lgkmcnt(15)
    v_mfma_f32_16x16x32_bf16 v[88:91], v[136:139], v[168:171], v[88:91]
    v_mfma_f32_16x16x32_bf16 v[84:87], v[136:139], v[164:167], v[84:87]
    v_mfma_f32_16x16x32_bf16 v[80:83], v[136:139], v[160:163], v[80:83]
    ds_read_b64_tr_b16 v[136:137], v25 offset:0
    ds_read_b64_tr_b16 v[138:139], v25 offset:1024
    v_mfma_f32_16x16x32_bf16 v[76:79], v[132:135], v[168:171], v[76:79]
    v_mfma_f32_16x16x32_bf16 v[72:75], v[132:135], v[164:167], v[72:75]
    v_mfma_f32_16x16x32_bf16 v[68:71], v[132:135], v[160:163], v[68:71]
    ds_read_b64_tr_b16 v[132:133], v24 offset:8192
    ds_read_b64_tr_b16 v[134:135], v24 offset:9216
    s_waitcnt lgkmcnt(8)
    v_mfma_f32_16x16x32_bf16 v[64:67], v[140:143], v[180:183], v[64:67]
    v_mfma_f32_16x16x32_bf16 v[60:63], v[140:143], v[176:179], v[60:63]
    v_mfma_f32_16x16x32_bf16 v[56:59], v[140:143], v[172:175], v[56:59]
    ds_read_b64_tr_b16 v[140:141], v25 offset:8192
    ds_read_b64_tr_b16 v[142:143], v25 offset:9216
    v_mfma_f32_16x16x32_bf16 v[100:103], v[168:171], v[152:155], v[100:103]
    s_nop 2
    v_cvt_pk_bf16_f32 v248, v64, v65
    v_cvt_pk_bf16_f32 v249, v66, v67
    v_mfma_f32_16x16x32_bf16 v[96:99], v[164:167], v[152:155], v[96:99]
    ds_write_b64 v8, v[248:249] offset:0
    v_cvt_pk_bf16_f32 v242, v60, v61
    v_mfma_f32_16x16x32_bf16 v[92:95], v[160:163], v[152:155], v[92:95]
    ds_read_b64_tr_b16 v[152:153], v18 offset:8192
    ds_read_b64_tr_b16 v[154:155], v18 offset:9216
    v_mfma_f32_16x16x32_bf16 v[76:79], v[144:147], v[180:183], v[76:79]
    v_cvt_pk_bf16_f32 v243, v62, v63
    v_cvt_pk_bf16_f32 v236, v56, v57
    v_mfma_f32_16x16x32_bf16 v[72:75], v[144:147], v[176:179], v[72:75]
    v_cvt_pk_bf16_f32 v237, v58, v59
    v_mfma_f32_16x16x32_bf16 v[68:71], v[144:147], v[172:175], v[68:71]
    ds_read_b64_tr_b16 v[144:145], v18 offset:0
    ds_read_b64_tr_b16 v[146:147], v18 offset:1024
    v_mfma_f32_16x16x32_bf16 v[88:91], v[148:151], v[180:183], v[88:91]
    v_cvt_pk_bf16_f32 v252, v76, v77
    v_cvt_pk_bf16_f32 v253, v78, v79
    v_mfma_f32_16x16x32_bf16 v[84:87], v[148:151], v[176:179], v[84:87]
    ds_write_b64 v8, v[252:253] offset:1024
    v_cvt_pk_bf16_f32 v246, v72, v73
    v_mfma_f32_16x16x32_bf16 v[80:83], v[148:151], v[172:175], v[80:83]
    ds_read_b64_tr_b16 v[148:149], v19 offset:0
    ds_read_b64_tr_b16 v[150:151], v19 offset:1024
    s_waitcnt lgkmcnt(15)
    v_mfma_f32_16x16x32_bf16 v[100:103], v[180:183], v[156:159], v[100:103]
    v_cvt_pk_bf16_f32 v6, v88, v89
    v_cvt_pk_bf16_f32 v7, v90, v91
    v_mfma_f32_16x16x32_bf16 v[96:99], v[176:179], v[156:159], v[96:99]
    v_permlane32_swap_b32 v6, v250
    v_mfma_f32_16x16x32_bf16 v[92:95], v[172:175], v[156:159], v[92:95]
    ds_read_b64_tr_b16 v[156:157], v19 offset:8192
    ds_read_b64_tr_b16 v[158:159], v19 offset:9216
    s_waitcnt lgkmcnt(15)
    v_mfma_f32_16x16x32_bf16 v[112:115], v[168:171], v[128:131], v[112:115]
    v_permlane32_swap_b32 v7, v251
    s_waitcnt lgkmcnt(14)
    v_mfma_f32_16x16x32_bf16 v[124:127], v[168:171], v[136:139], v[124:127]
    v_cvt_pk_bf16_f32 v206, v100, v101
    v_cvt_pk_bf16_f32 v207, v102, v103
    s_waitcnt lgkmcnt(12)
    v_mfma_f32_16x16x32_bf16 v[112:115], v[180:183], v[132:135], v[112:115]
    ds_write_b64 v8, v[250:251] offset:512
    ds_write_b64 v8, v[206:207] offset:1536
    s_waitcnt lgkmcnt(12)
    v_mfma_f32_16x16x32_bf16 v[124:127], v[180:183], v[140:143], v[124:127]
    v_cvt_pk_bf16_f32 v4, v84, v85
    v_cvt_pk_bf16_f32 v5, v86, v87
    s_waitcnt lgkmcnt(7)
    v_mfma_f32_16x16x32_bf16 v[40:43], v[144:147], v[168:171], v[40:43]
    v_permlane32_swap_b32 v4, v244
    v_mfma_f32_16x16x32_bf16 v[36:39], v[144:147], v[164:167], v[36:39]
    v_cvt_pk_bf16_f32 v214, v112, v113
    v_cvt_pk_bf16_f32 v215, v114, v115
    s_waitcnt lgkmcnt(4)
    v_mfma_f32_16x16x32_bf16 v[52:55], v[148:151], v[168:171], v[52:55]
    v_cvt_pk_bf16_f32 v222, v124, v125
    v_cvt_pk_bf16_f32 v223, v126, v127
    v_mfma_f32_16x16x32_bf16 v[48:51], v[148:151], v[164:167], v[48:51]
    ds_write_b64 v8, v[214:215] offset:2048
    ds_write_b64 v8, v[222:223] offset:2560
    v_mfma_f32_16x16x32_bf16 v[116:119], v[160:163], v[136:139], v[116:119]
    v_permlane32_swap_b32 v5, v245
    v_mfma_f32_16x16x32_bf16 v[32:35], v[144:147], v[160:163], v[32:35]
    v_cvt_pk_bf16_f32 v2, v80, v81
    v_cvt_pk_bf16_f32 v3, v82, v83
    v_mfma_f32_16x16x32_bf16 v[44:47], v[148:151], v[160:163], v[44:47]
    v_cvt_pk_bf16_f32 v247, v74, v75
    v_cvt_pk_bf16_f32 v240, v68, v69
    v_mfma_f32_16x16x32_bf16 v[40:43], v[152:155], v[180:183], v[40:43]
    s_waitcnt lgkmcnt(0)
    ds_write_b32 v31, v254
    v_mfma_f32_16x16x32_bf16 v[36:39], v[152:155], v[176:179], v[36:39]
    v_permlane32_swap_b32 v2, v238
    v_mfma_f32_16x16x32_bf16 v[52:55], v[156:159], v[180:183], v[52:55]
    v_permlane32_swap_b32 v3, v239
    v_mfma_f32_16x16x32_bf16 v[48:51], v[156:159], v[176:179], v[48:51]
    v_cvt_pk_bf16_f32 v241, v70, v71
    v_cndmask_b32 v66, v30, v6, s[60:61]
    v_mfma_f32_16x16x32_bf16 v[116:119], v[172:175], v[140:143], v[116:119]
    v_cndmask_b32 v67, v30, v7, s[60:61]
    v_cndmask_b32 v76, v30, v6, s[62:63]
    v_mfma_f32_16x16x32_bf16 v[32:35], v[152:155], v[172:175], v[32:35]
    v_cndmask_b32 v77, v30, v7, s[62:63]
    v_cndmask_b32 v62, v30, v4, s[60:61]
    v_mfma_f32_16x16x32_bf16 v[44:47], v[156:159], v[172:175], v[44:47]
    v_cndmask_b32 v63, v30, v5, s[60:61]
    v_cndmask_b32 v72, v30, v4, s[62:63]
    v_mfma_f32_16x16x32_bf16 v[108:111], v[164:167], v[128:131], v[108:111]
    v_cndmask_b32 v73, v30, v5, s[62:63]
    v_cvt_pk_bf16_f32 v64, v40, v41
    v_mfma_f32_16x16x32_bf16 v[104:107], v[160:163], v[128:131], v[104:107]
    v_cvt_pk_bf16_f32 v65, v42, v43
    v_cvt_pk_bf16_f32 v60, v36, v37
    v_mfma_f32_16x16x32_bf16 v[108:111], v[176:179], v[132:135], v[108:111]
    ds_read_b128 v[18:21], v255
    v_cvt_pk_bf16_f32 v61, v38, v39
    v_mfma_f32_16x16x32_bf16 v[104:107], v[172:175], v[132:135], v[104:107]
    v_cvt_pk_bf16_f32 v78, v52, v53
    v_cvt_pk_bf16_f32 v79, v54, v55
    v_mfma_f32_16x16x32_bf16 v[84:87], v[248:251], v[64:67], v[188:191]
    v_cvt_pk_bf16_f32 v74, v48, v49
    v_cvt_pk_bf16_f32 v75, v50, v51
    v_mfma_f32_16x16x32_bf16 v[80:83], v[242:245], v[64:67], v[184:187]
    v_cvt_pk_bf16_f32 v204, v96, v97
    v_cvt_pk_bf16_f32 v205, v98, v99
    v_mfma_f32_16x16x32_bf16 v[100:103], v[250:253], v[76:79], v[188:191]
    v_cvt_pk_bf16_f32 v218, v116, v117
    v_cvt_pk_bf16_f32 v219, v118, v119
    v_mfma_f32_16x16x32_bf16 v[96:99], v[244:247], v[76:79], v[184:187]
    v_cndmask_b32 v58, v30, v2, s[60:61]
    v_cndmask_b32 v59, v30, v3, s[60:61]
    v_mfma_f32_16x16x32_bf16 v[116:119], v[242:245], v[60:63], v[188:191]
    v_cndmask_b32 v68, v30, v2, s[62:63]
    v_cndmask_b32 v69, v30, v3, s[62:63]
    v_mfma_f32_16x16x32_bf16 v[112:115], v[236:239], v[60:63], v[192:195]
    v_cvt_pk_bf16_f32 v56, v32, v33
    v_cvt_pk_bf16_f32 v57, v34, v35
    v_mfma_f32_16x16x32_bf16 v[132:135], v[244:247], v[72:75], v[188:191]
    v_cvt_pk_bf16_f32 v70, v44, v45
    v_cvt_pk_bf16_f32 v71, v46, v47
    v_mfma_f32_16x16x32_bf16 v[128:131], v[238:241], v[72:75], v[192:195]
    v_max_f32 v80, v80, v84
    v_max_f32 v81, v81, v85
    v_mfma_f32_16x16x32_bf16 v[148:151], v[236:239], v[56:59], v[188:191]
    v_max_f32 v82, v82, v86
    v_max_f32 v96, v96, v100
    v_mfma_f32_16x16x32_bf16 v[36:39], v[238:241], v[68:71], v[188:191]
    v_max_f32 v97, v97, v101
    v_max_f32 v98, v98, v102
    v_mfma_f32_16x16x32_bf16 v[120:123], v[164:167], v[136:139], v[120:123]
    v_max_f32 v112, v112, v116
    v_max_f32 v113, v113, v117
    v_mfma_f32_16x16x32_bf16 v[120:123], v[176:179], v[140:143], v[120:123]
    s_waitcnt lgkmcnt(0)
    v_and_b32 v18, v18, v19
    v_and_b32 v20, v20, v21
    v_and_b32 v18, v18, v20
    s_mov_b32 s69, 0
    v_cmp_ne_u32 vcc, 1, v18
    s_cbranch_vccz L_xsok_40
L_xs_39:
    ds_read_b128 v[18:21], v255
    s_add_u32 s69, s69, 1
    s_cmp_gt_u32 s69, 1048576
    s_cbranch_scc1 L_xsok_40
    s_waitcnt lgkmcnt(0)
    v_and_b32 v18, v18, v19
    v_and_b32 v20, v20, v21
    v_and_b32 v18, v18, v20
    v_cmp_ne_u32 vcc, 1, v18
    s_cbranch_vccnz L_xs_39
L_xsok_40:
    s_waitcnt lgkmcnt(0)
    ds_read_b64 v[10:11], v1 offset:0
    ds_read_b64 v[12:13], v1 offset:512
    ds_read_b64 v[14:15], v1 offset:1024
    v_max_f32 v114, v114, v118
    v_max_f32 v128, v128, v132
    v_max_f32 v129, v129, v133
    v_max_f32 v130, v130, v134
    v_max_f32 v83, v83, v87
    v_max3_f32 v160, v80, v81, v82
    v_max_f32 v99, v99, v103
    v_max3_f32 v161, v96, v97, v98
    v_max_f32 v115, v115, v119
    v_max3_f32 v162, v112, v113, v114
    v_max_f32 v131, v131, v135
    v_max3_f32 v163, v128, v129, v130
    v_max_f32 v160, v160, v83
    v_max_f32 v161, v161, v99
    v_max_f32 v162, v162, v115
    v_max_f32 v163, v163, v131
    v_permlane32_swap_b32 v160, v161
    s_nop 0
    v_permlane32_swap_b32 v162, v163
    v_max_f32 v160, v160, v161
    v_max_f32 v162, v162, v163
    ds_read_b64 v[216:217], v1 offset:2560
    s_nop 0
    v_permlane16_swap_b32 v160, v162
    ds_read_b64 v[200:201], v1 offset:1536
    ds_read_b64 v[208:209], v1 offset:2048
    v_max_f32 v160, v160, v162
    v_cvt_pk_bf16_f32 v203, v94, v95
    v_mul_f32 v160, s64, v160
    v_cvt_pk_bf16_f32 v213, v110, v111
    s_waitcnt lgkmcnt(4)
    v_mfma_f32_16x16x32_bf16 v[144:147], v[10:13], v[56:59], v[184:187]
    v_mov_b32 v162, v160
    v_cvt_pk_bf16_f32 v202, v92, v93
    s_waitcnt lgkmcnt(3)
    v_mfma_f32_16x16x32_bf16 v[32:35], v[12:15], v[68:71], v[184:187]
    v_permlane16_swap_b32 v160, v162
    v_cvt_pk_bf16_f32 v212, v108, v109
    v_mov_b32 v161, v160
    v_mov_b32 v163, v162
    v_max_f32 v144, v144, v148
    v_max_f32 v145, v145, v149
    v_max_f32 v146, v146, v150
    v_max_f32 v147, v147, v151
    v_max_f32 v32, v32, v36
    v_max_f32 v33, v33, v37
    v_max_f32 v34, v34, v38
    v_max3_f32 v164, v144, v145, v146
    v_max_f32 v35, v35, v39
    v_max3_f32 v165, v32, v33, v34
    v_max_f32 v164, v164, v147
    v_max_f32 v165, v165, v35
    v_permlane32_swap_b32 v160, v161
    s_nop 0
    v_permlane32_swap_b32 v164, v165
    v_permlane32_swap_b32 v162, v163
    v_max_f32 v164, v164, v165
    v_pk_fma_f32 v[80:81], v[80:81], s[64:65], v[160:161] op_sel:[0,0,0] op_sel_hi:[1,1,0] neg_lo:[0,0,1] neg_hi:[0,0,1]
    v_mov_b32 v165, v164
    v_pk_fma_f32 v[82:83], v[82:83], s[64:65], v[160:161] op_sel:[0,0,0] op_sel_hi:[1,1,0] neg_lo:[0,0,1] neg_hi:[0,0,1]
    s_nop 0
    v_permlane16_swap_b32 v164, v165
    v_pk_fma_f32 v[96:97], v[96:97], s[64:65], v[160:161] op_sel:[0,0,1] op_sel_hi:[1,1,1] neg_lo:[0,0,1] neg_hi:[0,0,1]
    v_max_f32 v164, v164, v165
    v_pk_fma_f32 v[98:99], v[98:99], s[64:65], v[160:161] op_sel:[0,0,1] op_sel_hi:[1,1,1] neg_lo:[0,0,1] neg_hi:[0,0,1]
    v_mul_f32 v164, s64, v164
    v_pk_fma_f32 v[112:113], v[112:113], s[64:65], v[162:163] op_sel:[0,0,0] op_sel_hi:[1,1,0] neg_lo:[0,0,1] neg_hi:[0,0,1]
    v_mov_b32 v165, v164
    v_pk_fma_f32 v[114:115], v[114:115], s[64:65], v[162:163] op_sel:[0,0,0] op_sel_hi:[1,1,0] neg_lo:[0,0,1] neg_hi:[0,0,1]
    s_nop 0
    v_permlane32_swap_b32 v164, v165
    v_pk_fma_f32 v[128:129], v[128:129], s[64:65], v[162:163] op_sel:[0,0,1] op_sel_hi:[1,1,1] neg_lo:[0,0,1] neg_hi:[0,0,1]
    v_pk_fma_f32 v[130:131], v[130:131], s[64:65], v[162:163] op_sel:[0,0,1] op_sel_hi:[1,1,1] neg_lo:[0,0,1] neg_hi:[0,0,1]
    v_pk_fma_f32 v[144:145], v[144:145], s[64:65], v[164:165] op_sel:[0,0,0] op_sel_hi:[1,1,0] neg_lo:[0,0,1] neg_hi:[0,0,1]
    v_pk_fma_f32 v[146:147], v[146:147], s[64:65], v[164:165] op_sel:[0,0,0] op_sel_hi:[1,1,0] neg_lo:[0,0,1] neg_hi:[0,0,1]
    v_pk_fma_f32 v[32:33], v[32:33], s[64:65], v[164:165] op_sel:[0,0,1] op_sel_hi:[1,1,1] neg_lo:[0,0,1] neg_hi:[0,0,1]
    v_pk_fma_f32 v[34:35], v[34:35], s[64:65], v[164:165] op_sel:[0,0,1] op_sel_hi:[1,1,1] neg_lo:[0,0,1] neg_hi:[0,0,1]
    v_exp_f32 v80, v80
    v_exp_f32 v81, v81
    v_exp_f32 v82, v82
    v_exp_f32 v83, v83
    v_exp_f32 v96, v96
    v_exp_f32 v97, v97
    v_exp_f32 v98, v98
    v_exp_f32 v99, v99
    v_exp_f32 v112, v112
    v_exp_f32 v113, v113
    v_exp_f32 v114, v114
    v_exp_f32 v115, v115
    v_exp_f32 v128, v128
    v_exp_f32 v129, v129
    v_exp_f32 v130, v130
    v_exp_f32 v131, v131
    v_exp_f32 v144, v144
    v_exp_f32 v145, v145
    v_exp_f32 v146, v146
    v_exp_f32 v147, v147
    v_exp_f32 v32, v32
    v_exp_f32 v33, v33
    v_exp_f32 v34, v34
    v_exp_f32 v35, v35
    v_cvt_pk_bf16_f32 v94, v80, v81
    v_cvt_pk_bf16_f32 v95, v82, v83
    v_cvt_pk_bf16_f32 v110, v96, v97
    v_cvt_pk_bf16_f32 v111, v98, v99
    v_cvt_pk_bf16_f32 v126, v112, v113
    v_cvt_pk_bf16_f32 v127, v114, v115
    v_cvt_pk_bf16_f32 v142, v128, v129
    v_cvt_pk_bf16_f32 v143, v130, v131
    v_cvt_pk_bf16_f32 v158, v144, v145
    v_cvt_pk_bf16_f32 v159, v146, v147
    v_cvt_pk_bf16_f32 v46, v32, v33
    v_cvt_pk_bf16_f32 v47, v34, v35
    v_and_b32 v92, v196, v94
    v_and_b32 v93, v197, v95
    v_and_b32 v108, v196, v110
    v_and_b32 v109, v197, v111
    v_and_b32 v124, v196, v126
    v_and_b32 v125, v197, v127
    v_and_b32 v140, v196, v142
    v_and_b32 v141, v197, v143
    v_and_b32 v156, v196, v158
    v_and_b32 v157, v197, v159
    v_and_b32 v44, v196, v46
    v_and_b32 v45, v197, v47
    v_xor_b32 v94, v92, v94
    v_xor_b32 v95, v93, v95
    v_xor_b32 v110, v108, v110
    s_nop 0
    v_mfma_f32_16x16x32_bf16 v[88:91], v[224:227], v[92:95], 0
    v_xor_b32 v111, v109, v111
    v_xor_b32 v126, v124, v126
    v_mfma_f32_16x16x32_bf16 v[80:83], v[204:207], v[92:95], 0
    v_xor_b32 v127, v125, v127
    v_xor_b32 v142, v140, v142
    v_mfma_f32_16x16x32_bf16 v[96:99], v[212:215], v[108:111], 0
    v_xor_b32 v143, v141, v143
    v_xor_b32 v158, v156, v158
    s_nop 0
    v_mfma_f32_16x16x32_bf16 v[136:139], v[224:227], v[140:143], 0
    v_xor_b32 v159, v157, v159
    v_xor_b32 v46, v44, v46
    s_nop 0
    v_mfma_f32_16x16x32_bf16 v[152:155], v[224:227], v[156:159], 0
    v_xor_b32 v47, v45, v47
    v_cvt_pk_bf16_f32 v210, v104, v105
    s_nop 0
    v_mfma_f32_16x16x32_bf16 v[40:43], v[224:227], v[44:47], 0
    v_cvt_pk_bf16_f32 v211, v106, v107
    v_cvt_pk_bf16_f32 v220, v120, v121
    v_mfma_f32_16x16x32_bf16 v[104:107], v[224:227], v[108:111], 0
    v_cvt_pk_bf16_f32 v221, v122, v123
    v_rcp_f32 v88, v88
    v_mfma_f32_16x16x32_bf16 v[120:123], v[224:227], v[124:127], 0
    v_rcp_f32 v136, v136
    v_mfma_f32_16x16x32_bf16 v[84:87], v[220:223], v[92:95], 0
    s_nop 2
    v_rcp_f32 v104, v104
    v_mfma_f32_16x16x32_bf16 v[100:103], v[220:223], v[108:111], 0
    v_rcp_f32 v152, v152
    v_mfma_f32_16x16x32_bf16 v[116:119], v[218:221], v[124:127], 0
    v_rcp_f32 v120, v120
    v_mfma_f32_16x16x32_bf16 v[132:135], v[218:221], v[140:143], 0
    v_rcp_f32 v40, v40
    s_waitcnt lgkmcnt(2)
    v_mfma_f32_16x16x32_bf16 v[148:151], v[216:219], v[156:159], 0
    s_nop 0
    v_cndmask_b32 v84, v100, v84, s[60:61]
    v_cndmask_b32 v85, v101, v85, s[60:61]
    v_mfma_f32_16x16x32_bf16 v[36:39], v[216:219], v[44:47], 0
    v_cndmask_b32 v86, v102, v86, s[60:61]
    v_cndmask_b32 v87, v103, v87, s[60:61]
    v_mfma_f32_16x16x32_bf16 v[112:115], v[202:205], v[124:127], 0
    v_cndmask_b32 v89, v104, v88, s[60:61]
    v_cndmask_b32 v116, v132, v116, s[60:61]
    v_mfma_f32_16x16x32_bf16 v[128:131], v[210:213], v[140:143], 0
    v_cndmask_b32 v117, v133, v117, s[60:61]
    v_cndmask_b32 v118, v134, v118, s[60:61]
    s_waitcnt lgkmcnt(1)
    v_mfma_f32_16x16x32_bf16 v[144:147], v[200:203], v[156:159], 0
    v_cndmask_b32 v119, v135, v119, s[60:61]
    v_cndmask_b32 v121, v136, v120, s[60:61]
    s_waitcnt lgkmcnt(0)
    v_mfma_f32_16x16x32_bf16 v[32:35], v[208:211], v[44:47], 0
    v_cndmask_b32 v148, v36, v148, s[60:61]
    v_cndmask_b32 v149, v37, v149, s[60:61]
    v_cndmask_b32 v150, v38, v150, s[60:61]
    v_cndmask_b32 v151, v39, v151, s[60:61]
    v_cndmask_b32 v153, v40, v152, s[60:61]
    v_pk_mul_f32 v[80:81], v[80:81], v[88:89] op_sel:[0,0] op_sel_hi:[1,0]
    v_pk_mul_f32 v[96:97], v[96:97], v[104:105] op_sel:[0,0] op_sel_hi:[1,0]
    v_pk_mul_f32 v[84:85], v[84:85], v[88:89] op_sel:[0,1] op_sel_hi:[1,1]
    v_pk_mul_f32 v[82:83], v[82:83], v[88:89] op_sel:[0,0] op_sel_hi:[1,0]
    v_pk_mul_f32 v[98:99], v[98:99], v[104:105] op_sel:[0,0] op_sel_hi:[1,0]
    v_pk_mul_f32 v[86:87], v[86:87], v[88:89] op_sel:[0,1] op_sel_hi:[1,1]
    v_pk_mul_f32 v[112:113], v[112:113], v[120:121] op_sel:[0,0] op_sel_hi:[1,0]
    v_pk_mul_f32 v[128:129], v[128:129], v[136:137] op_sel:[0,0] op_sel_hi:[1,0]
    v_pk_mul_f32 v[116:117], v[116:117], v[120:121] op_sel:[0,1] op_sel_hi:[1,1]
    v_pk_mul_f32 v[114:115], v[114:115], v[120:121] op_sel:[0,0] op_sel_hi:[1,0]
    v_pk_mul_f32 v[130:131], v[130:131], v[136:137] op_sel:[0,0] op_sel_hi:[1,0]
    v_pk_mul_f32 v[118:119], v[118:119], v[120:121] op_sel:[0,1] op_sel_hi:[1,1]
    v_pk_mul_f32 v[144:145], v[144:145], v[152:153] op_sel:[0,0] op_sel_hi:[1,0]
    v_pk_mul_f32 v[32:33], v[32:33], v[40:41] op_sel:[0,0] op_sel_hi:[1,0]
    v_pk_mul_f32 v[148:149], v[148:149], v[152:153] op_sel:[0,1] op_sel_hi:[1,1]
    v_pk_mul_f32 v[146:147], v[146:147], v[152:153] op_sel:[0,0] op_sel_hi:[1,0]
    v_pk_mul_f32 v[34:35], v[34:35], v[40:41] op_sel:[0,0] op_sel_hi:[1,0]
    v_pk_mul_f32 v[150:151], v[150:151], v[152:153] op_sel:[0,1] op_sel_hi:[1,1]
    v_cvt_pk_bf16_f32 v166, v80, v81
    v_cvt_pk_bf16_f32 v167, v82, v83
    v_cvt_pk_bf16_f32 v168, v96, v97
    v_cvt_pk_bf16_f32 v169, v98, v99
    v_cvt_pk_bf16_f32 v170, v84, v85
    buffer_store_dwordx4 v[166:169], v16, s[44:47], 0 offen sc1
    v_cvt_pk_bf16_f32 v171, v86, v87
    v_cvt_pk_bf16_f32 v172, v112, v113
    buffer_store_dwordx2 v[170:171], v17, s[44:47], 0 offen sc1
    v_cvt_pk_bf16_f32 v173, v114, v115
    v_cvt_pk_bf16_f32 v174, v128, v129
    v_cvt_pk_bf16_f32 v175, v130, v131
    v_cvt_pk_bf16_f32 v176, v116, v117
    buffer_store_dwordx4 v[172:175], v26, s[44:47], 0 offen sc1
    v_cvt_pk_bf16_f32 v177, v118, v119
    v_cvt_pk_bf16_f32 v178, v144, v145
    buffer_store_dwordx2 v[176:177], v27, s[44:47], 0 offen sc1
    v_cvt_pk_bf16_f32 v179, v146, v147
    v_cvt_pk_bf16_f32 v180, v32, v33
    v_cvt_pk_bf16_f32 v181, v34, v35
    v_cvt_pk_bf16_f32 v182, v148, v149
    buffer_store_dwordx4 v[178:181], v198, s[44:47], 0 offen sc1
    v_cvt_pk_bf16_f32 v183, v150, v151
    buffer_store_dwordx2 v[182:183], v199, s[44:47], 0 offen sc1
    s_lshl_b32 s69, s49, 2
    s_add_u32 s69, s69, 159808
    v_mov_b32 v2, s69
    v_mov_b32 v3, 1
    ds_write_b32 v2, v3
    s_lshl_b32 s60, s52, 2
    s_add_u32 s60, s60, s49
    s_lshl_b32 s60, s60, 8
    s_add_u32 s60, s60, 5898240
    s_waitcnt vmcnt(0)
    v_mov_b32 v4, 1
    v_mov_b32 v5, 1
    s_mov_b64 exec, 1
    buffer_atomic_add v4, v30, s[44:47], s60 offen sc0 sc1
    s_waitcnt vmcnt(0)
    v_cmp_eq_u32 vcc, 15, v4
    s_cbranch_vccz L_notlast_41
    buffer_store_dword v5, v30, s[44:47], s60 offen offset:128 sc1
L_notlast_41:
    s_mov_b64 exec, -1
    s_lshl_b32 s69, s49, 2
    s_add_u32 s69, s69, 159792
    v_mov_b32 v2, s69
    v_mov_b32 v3, 1
    ds_write_b32 v2, v3
L_fin:
    s_endpgm
L_B:
    s_lshl_b32 s57, s50, 3
    s_add_u32 s57, s57, s51
    s_lshl_b32 s60, s48, 6
    s_mov_b32 s61, 3
    s_mul_i32 s62, s51, 192
    s_add_u32 s60, s60, s62
    s_cmp_lt_u32 s51, 5
    s_cbranch_scc0 L_B_pfx
    v_add_u32 v1, s60, v0
    v_mul_u32_u24 v2, 4370, v1
    v_lshrrev_b32 v2, 16, v2
    v_mul_u32_u24 v3, 15, v2
    v_sub_u32 v3, v1, v3
    v_mul_u32_u24 v20, 52, v3
    v_lshrrev_b32 v20, 8, v20
    v_mul_u32_u24 v20, 640, v20
    v_lshl_add_u32 v20, v3, 7, v20
    v_mul_u32_u24 v2, 3840, v2
    s_and_b32 s62, s50, 1
    s_mul_i32 s62, s62, 640
    v_add3_u32 v20, v20, v2, s62
    s_waitcnt lgkmcnt(0)
    s_mov_b32 s20, s6
    s_and_b32 s21, s7, 0xffff
    s_mov_b32 s22, 0x258000
    s_mov_b32 s23, 0x20000
    s_mov_b32 s62, 245760
    s_branch L_B_pfd
L_B_pfx:
    s_sub_u32 s60, s60, 960
    v_add_u32 v1, s60, v0
    s_and_b32 s62, s2, 4
    s_mulk_i32 s62, 124
    v_add_u32 v2, s62, v1
    s_bfe_u32 s62, s2, 0x10001
    v_lshl_add_u32 v2, v2, 1, s62
    v_mul_u32_u24 v20, 1280, v2
    v_cmp_lt_u32 vcc, 527, v1
    v_bfrev_b32 v3, 1
    s_nop 0
    v_cndmask_b32 v20, v20, v3, vcc
    s_waitcnt lgkmcnt(0)
    s_mov_b32 s20, s4
    s_and_b32 s21, s5, 0xffff
    s_mov_b32 s22, 0x280000
    s_mov_b32 s23, 0x20000
    s_movk_i32 s62, 128
L_B_pfd:
    s_mul_i32 s18, s61, s62
    s_lshl_b32 s19, s62, 0
    s_sub_u32 s61, 10, s61
    s_lshr_b32 s61, s61, 0
    s_cmp_lt_u32 s48, 3
    s_cselect_b32 s71, s61, 0
    s_mov_b32 s32, s10
    s_and_b32 s33, s11, 0xffff
    s_mov_b32 s34, 0x280000
    s_mov_b32 s35, 0x20000
    s_lshl_b32 s60, s48, 6
    s_add_u32 s60, s60, 0
    v_add_u32 v1, s60, v0
    v_mul_u32_u24 v2, 3277, v1
    v_lshrrev_b32 v2, 16, v2
    v_mul_u32_u24 v3, 20, v2
    v_sub_u32 v3, v1, v3
    v_lshl_add_u32 v4, v2, 6, s57
    v_mul_u32_u24 v4, 1280, v4
    v_lshl_add_u32 v10, v3, 4, v4
    buffer_load_dwordx4 v[24:27], v10, s[32:35], 0 offen offset:0
    buffer_load_dwordx4 v[28:31], v10, s[32:35], 0 offen offset:320
    buffer_load_dwordx4 v[32:35], v10, s[32:35], 0 offen offset:640
    buffer_load_dwordx4 v[36:39], v10, s[32:35], 0 offen offset:960
    v_lshrrev_b32 v4, 4, v2
    v_mul_u32_u24 v4, 5, v4
    v_lshrrev_b32 v5, 2, v3
    v_add_u32 v4, v4, v5
    v_lshlrev_b32 v4, 10, v4
    v_and_b32 v6, 3, v3
    v_lshl_add_u32 v4, v6, 8, v4
    v_and_b32 v5, 1, v5
    v_mul_u32_u24 v5, 12, v5
    v_or_b32 v5, v5, v6
    v_and_b32 v2, 15, v2
    v_xor_b32 v2, v2, v5
    v_lshl_add_u32 v4, v2, 4, v4
    v_add_u32 v12, 106496, v4
    s_lshl_b32 s60, s48, 6
    s_add_u32 s60, s60, 384
    v_add_u32 v1, s60, v0
    v_mul_u32_u24 v2, 3277, v1
    v_lshrrev_b32 v2, 16, v2
    v_mul_u32_u24 v3, 20, v2
    v_sub_u32 v3, v1, v3
    v_lshl_add_u32 v4, v2, 6, s57
    v_mul_u32_u24 v4, 1280, v4
    v_lshl_add_u32 v11, v3, 4, v4
    s_sub_u32 s59, s48, 2
    s_cmp_ge_u32 s59, 2
    s_cbranch_scc1 L_B_ld0
    buffer_load_dwordx4 v[40:43], v11, s[32:35], 0 offen offset:0
    buffer_load_dwordx4 v[44:47], v11, s[32:35], 0 offen offset:320
    buffer_load_dwordx4 v[48:51], v11, s[32:35], 0 offen offset:640
    buffer_load_dwordx4 v[52:55], v11, s[32:35], 0 offen offset:960
L_B_ld0:
    v_lshrrev_b32 v4, 4, v2
    v_mul_u32_u24 v4, 5, v4
    v_lshrrev_b32 v5, 2, v3
    v_add_u32 v4, v4, v5
    v_lshlrev_b32 v4, 10, v4
    v_and_b32 v6, 3, v3
    v_lshl_add_u32 v4, v6, 8, v4
    v_and_b32 v5, 1, v5
    v_mul_u32_u24 v5, 12, v5
    v_or_b32 v5, v5, v6
    v_and_b32 v2, 15, v2
    v_xor_b32 v2, v2, v5
    v_lshl_add_u32 v4, v2, 4, v4
    v_add_u32 v13, 106496, v4
    s_mov_b32 s28, s8
    s_and_b32 s29, s9, 0xffff
    s_mov_b32 s30, 0xc8000
    s_mov_b32 s31, 0x20000
    s_mov_b32 s36, s12
    s_and_b32 s37, s13, 0xffff
    s_mov_b32 s38, 0x500000
    s_mov_b32 s39, 0x20000
    s_mov_b32 s40, s14
    s_and_b32 s41, s15, 0xffff
    s_mov_b32 s42, 0x100
    s_mov_b32 s43, 0x20000
    s_mov_b32 s44, s16
    s_and_b32 s45, s17, 0xffff
    s_mov_b32 s46, 0x10000000
    s_mov_b32 s47, 0x20000
    s_cmp_ge_u32 s48, 4
    s_cbranch_scc1 L_B_light
    s_and_b32 s69, s48, 1
    s_lshl_b32 s58, s69, 1
    s_add_u32 s58, s58, 1
    s_lshr_b32 s3, s48, 1
    s_sub_u32 s68, 3, s3
    s_mul_i32 s3, s3, 3
    s_add_u32 s59, s3, 0
    s_lshl_b32 s60, s59, 6
    s_add_u32 s60, s60, s58
    s_lshl_b32 s64, s59, 11
    s_mul_i32 s59, s58, 10240
    s_add_u32 s64, s64, s59
    s_add_u32 s59, s3, 1
    s_lshl_b32 s61, s59, 6
    s_add_u32 s61, s61, s58
    s_lshl_b32 s65, s59, 11
    s_mul_i32 s59, s58, 10240
    s_add_u32 s65, s65, s59
    s_add_u32 s59, s3, 2
    s_lshl_b32 s62, s59, 6
    s_add_u32 s62, s62, s58
    s_lshl_b32 s66, s59, 11
    s_mul_i32 s59, s58, 10240
    s_add_u32 s66, s66, s59
    s_lshl_b32 s69, s69, 31
    s_or_b32 s3, s69, 0x3f800000
    s_branch L_B_par
L_B_light:
    s_lshl_b32 s3, s49, 2
    s_sub_u32 s3, s3, 1
    s_max_i32 s3, s3, 0
    s_cmp_eq_u32 s49, 0
    s_cselect_b32 s68, 3, 4
    s_add_u32 s59, s3, 0
    s_mul_i32 s58, s59, 52
    s_lshr_b32 s58, s58, 8
    s_mul_i32 s69, s58, 5
    s_sub_u32 s59, s59, s69
    s_lshl_b32 s69, s58, 2
    s_cmp_eq_u32 s58, 2
    s_cselect_b32 s58, 2, s69
    s_lshl_b32 s60, s59, 6
    s_add_u32 s60, s60, s58
    s_lshl_b32 s64, s59, 11
    s_mul_i32 s59, s58, 10240
    s_add_u32 s64, s64, s59
    s_add_u32 s59, s3, 1
    s_mul_i32 s58, s59, 52
    s_lshr_b32 s58, s58, 8
    s_mul_i32 s69, s58, 5
    s_sub_u32 s59, s59, s69
    s_lshl_b32 s69, s58, 2
    s_cmp_eq_u32 s58, 2
    s_cselect_b32 s58, 2, s69
    s_lshl_b32 s61, s59, 6
    s_add_u32 s61, s61, s58
    s_lshl_b32 s65, s59, 11
    s_mul_i32 s59, s58, 10240
    s_add_u32 s65, s65, s59
    s_add_u32 s59, s3, 2
    s_mul_i32 s58, s59, 52
    s_lshr_b32 s58, s58, 8
    s_mul_i32 s69, s58, 5
    s_sub_u32 s59, s59, s69
    s_lshl_b32 s69, s58, 2
    s_cmp_eq_u32 s58, 2
    s_cselect_b32 s58, 2, s69
    s_lshl_b32 s62, s59, 6
    s_add_u32 s62, s62, s58
    s_lshl_b32 s66, s59, 11
    s_mul_i32 s59, s58, 10240
    s_add_u32 s66, s66, s59
    s_add_u32 s59, s3, 3
    s_mul_i32 s58, s59, 52
    s_lshr_b32 s58, s58, 8
    s_mul_i32 s69, s58, 5
    s_sub_u32 s59, s59, s69
    s_lshl_b32 s69, s58, 2
    s_cmp_eq_u32 s58, 2
    s_cselect_b32 s58, 2, s69
    s_lshl_b32 s63, s59, 6
    s_add_u32 s63, s63, s58
    s_lshl_b32 s67, s59, 11
    s_mul_i32 s59, s58, 10240
    s_add_u32 s67, s67, s59
L_B_par:
    v_and_b32 v14, 15, v0
    v_lshrrev_b32 v15, 4, v0
    v_lshlrev_b32 v1, 3, v15
    v_cvt_f32_u32 v22, v1
    s_xor_b32 s59, s48, 4
    s_or_b32 s70, s57, s59
    s_cmp_lg_u32 s70, 0
    s_cbranch_scc1 L_B_noclr
    s_mov_b32 s58, 5898240
    v_mov_b32 v4, 0
    v_lshlrev_b32 v1, 7, v0
    buffer_store_dword v4, v1, s[44:47], s58 offen sc1
    s_add_u32 s58, s58, 5120
    buffer_store_dword v4, v1, s[44:47], s58 offen sc1
L_B_noclr:
    v_lshl_add_u32 v1, v14, 2, s60
    v_cvt_f32_u32 v1, v1
    v_mul_f32 v1, 0x3acccccd, v1
    v_mul_f32 v2, v1, v22
    v_mul_f32 v9, 0x42000000, v1
    v_cos_f32 v8, v1
    v_cos_f32 v9, v9
    v_fmamk_f32 v3, v1, 0x0, v2
    v_fmamk_f32 v56, v1, 0x3f800000, v2
    v_cos_f32 v4, v3
    v_cos_f32 v6, v56
    v_sin_f32 v5, -v3
    v_sin_f32 v7, -v56
    v_add_f32 v8, v8, v8
    v_add_f32 v9, v9, v9
    v_cvt_pk_bf16_f32 v96, v4, v6
    v_pk_fma_f32 v[56:57], v[8:9], v[6:7], v[4:5] op_sel:[0,0,0] op_sel_hi:[0,1,1] neg_lo:[0,0,1] neg_hi:[0,0,1]
    v_cvt_pk_bf16_f32 v100, v5, v7
    v_pk_fma_f32 v[58:59], v[8:9], v[56:57], v[6:7] op_sel:[0,0,0] op_sel_hi:[0,1,1] neg_lo:[0,0,1] neg_hi:[0,0,1]
    v_pk_fma_f32 v[60:61], v[8:9], v[58:59], v[56:57] op_sel:[0,0,0] op_sel_hi:[0,1,1] neg_lo:[0,0,1] neg_hi:[0,0,1]
    v_cvt_pk_bf16_f32 v97, v56, v58
    v_pk_fma_f32 v[62:63], v[8:9], v[60:61], v[58:59] op_sel:[0,0,0] op_sel_hi:[0,1,1] neg_lo:[0,0,1] neg_hi:[0,0,1]
    v_cvt_pk_bf16_f32 v101, v57, v59
    v_pk_fma_f32 v[64:65], v[8:9], v[62:63], v[60:61] op_sel:[0,0,0] op_sel_hi:[0,1,1] neg_lo:[0,0,1] neg_hi:[0,0,1]
    v_cvt_pk_bf16_f32 v98, v60, v62
    v_pk_fma_f32 v[66:67], v[8:9], v[64:65], v[62:63] op_sel:[0,0,0] op_sel_hi:[0,1,1] neg_lo:[0,0,1] neg_hi:[0,0,1]
    v_cvt_pk_bf16_f32 v102, v61, v63
    v_cvt_pk_bf16_f32 v99, v64, v66
    v_cvt_pk_bf16_f32 v103, v65, v67
    v_fmamk_f32 v3, v1, 0x42000000, v2
    v_fmamk_f32 v56, v1, 0x42040000, v2
    v_cos_f32 v16, v3
    v_cos_f32 v18, v56
    v_sin_f32 v17, -v3
    v_sin_f32 v19, -v56
    v_cvt_pk_bf16_f32 v104, v16, v18
    v_pk_fma_f32 v[56:57], v[8:9], v[18:19], v[16:17] op_sel:[0,0,0] op_sel_hi:[0,1,1] neg_lo:[0,0,1] neg_hi:[0,0,1]
    v_cvt_pk_bf16_f32 v108, v17, v19
    v_pk_fma_f32 v[58:59], v[8:9], v[56:57], v[18:19] op_sel:[0,0,0] op_sel_hi:[0,1,1] neg_lo:[0,0,1] neg_hi:[0,0,1]
    v_pk_fma_f32 v[60:61], v[8:9], v[58:59], v[56:57] op_sel:[0,0,0] op_sel_hi:[0,1,1] neg_lo:[0,0,1] neg_hi:[0,0,1]
    v_cvt_pk_bf16_f32 v105, v56, v58
    v_pk_fma_f32 v[62:63], v[8:9], v[60:61], v[58:59] op_sel:[0,0,0] op_sel_hi:[0,1,1] neg_lo:[0,0,1] neg_hi:[0,0,1]
    v_cvt_pk_bf16_f32 v109, v57, v59
    v_pk_fma_f32 v[64:65], v[8:9], v[62:63], v[60:61] op_sel:[0,0,0] op_sel_hi:[0,1,1] neg_lo:[0,0,1] neg_hi:[0,0,1]
    v_cvt_pk_bf16_f32 v106, v60, v62
    v_pk_fma_f32 v[66:67], v[8:9], v[64:65], v[62:63] op_sel:[0,0,0] op_sel_hi:[0,1,1] neg_lo:[0,0,1] neg_hi:[0,0,1]
    v_cvt_pk_bf16_f32 v110, v61, v63
    v_cvt_pk_bf16_f32 v107, v64, v66
    v_cvt_pk_bf16_f32 v111, v65, v67
    v_pk_fma_f32 v[4:5], v[8:9], v[16:17], v[4:5] op_sel:[1,0,0] op_sel_hi:[1,1,1] neg_lo:[0,0,1] neg_hi:[0,0,1]
    v_pk_fma_f32 v[6:7], v[8:9], v[18:19], v[6:7] op_sel:[1,0,0] op_sel_hi:[1,1,1] neg_lo:[0,0,1] neg_hi:[0,0,1]
    v_cvt_pk_bf16_f32 v112, v4, v6
    v_pk_fma_f32 v[56:57], v[8:9], v[6:7], v[4:5] op_sel:[0,0,0] op_sel_hi:[0,1,1] neg_lo:[0,0,1] neg_hi:[0,0,1]
    v_cvt_pk_bf16_f32 v116, v5, v7
    v_pk_fma_f32 v[58:59], v[8:9], v[56:57], v[6:7] op_sel:[0,0,0] op_sel_hi:[0,1,1] neg_lo:[0,0,1] neg_hi:[0,0,1]
    v_pk_fma_f32 v[60:61], v[8:9], v[58:59], v[56:57] op_sel:[0,0,0] op_sel_hi:[0,1,1] neg_lo:[0,0,1] neg_hi:[0,0,1]
    v_cvt_pk_bf16_f32 v113, v56, v58
    v_pk_fma_f32 v[62:63], v[8:9], v[60:61], v[58:59] op_sel:[0,0,0] op_sel_hi:[0,1,1] neg_lo:[0,0,1] neg_hi:[0,0,1]
    v_cvt_pk_bf16_f32 v117, v57, v59
    v_pk_fma_f32 v[64:65], v[8:9], v[62:63], v[60:61] op_sel:[0,0,0] op_sel_hi:[0,1,1] neg_lo:[0,0,1] neg_hi:[0,0,1]
    v_cvt_pk_bf16_f32 v114, v60, v62
    v_pk_fma_f32 v[66:67], v[8:9], v[64:65], v[62:63] op_sel:[0,0,0] op_sel_hi:[0,1,1] neg_lo:[0,0,1] neg_hi:[0,0,1]
    v_cvt_pk_bf16_f32 v118, v61, v63
    v_cvt_pk_bf16_f32 v115, v64, v66
    v_cvt_pk_bf16_f32 v119, v65, v67
    v_pk_fma_f32 v[16:17], v[8:9], v[4:5], v[16:17] op_sel:[1,0,0] op_sel_hi:[1,1,1] neg_lo:[0,0,1] neg_hi:[0,0,1]
    v_pk_fma_f32 v[18:19], v[8:9], v[6:7], v[18:19] op_sel:[1,0,0] op_sel_hi:[1,1,1] neg_lo:[0,0,1] neg_hi:[0,0,1]
    v_cvt_pk_bf16_f32 v120, v16, v18
    v_pk_fma_f32 v[56:57], v[8:9], v[18:19], v[16:17] op_sel:[0,0,0] op_sel_hi:[0,1,1] neg_lo:[0,0,1] neg_hi:[0,0,1]
    v_cvt_pk_bf16_f32 v124, v17, v19
    v_pk_fma_f32 v[58:59], v[8:9], v[56:57], v[18:19] op_sel:[0,0,0] op_sel_hi:[0,1,1] neg_lo:[0,0,1] neg_hi:[0,0,1]
    v_pk_fma_f32 v[60:61], v[8:9], v[58:59], v[56:57] op_sel:[0,0,0] op_sel_hi:[0,1,1] neg_lo:[0,0,1] neg_hi:[0,0,1]
    v_cvt_pk_bf16_f32 v121, v56, v58
    v_pk_fma_f32 v[62:63], v[8:9], v[60:61], v[58:59] op_sel:[0,0,0] op_sel_hi:[0,1,1] neg_lo:[0,0,1] neg_hi:[0,0,1]
    v_cvt_pk_bf16_f32 v125, v57, v59
    v_pk_fma_f32 v[64:65], v[8:9], v[62:63], v[60:61] op_sel:[0,0,0] op_sel_hi:[0,1,1] neg_lo:[0,0,1] neg_hi:[0,0,1]
    v_cvt_pk_bf16_f32 v122, v60, v62
    v_pk_fma_f32 v[66:67], v[8:9], v[64:65], v[62:63] op_sel:[0,0,0] op_sel_hi:[0,1,1] neg_lo:[0,0,1] neg_hi:[0,0,1]
    v_cvt_pk_bf16_f32 v126, v61, v63
    v_cvt_pk_bf16_f32 v123, v64, v66
    v_cvt_pk_bf16_f32 v127, v65, v67
    v_pk_fma_f32 v[4:5], v[8:9], v[16:17], v[4:5] op_sel:[1,0,0] op_sel_hi:[1,1,1] neg_lo:[0,0,1] neg_hi:[0,0,1]
    v_pk_fma_f32 v[6:7], v[8:9], v[18:19], v[6:7] op_sel:[1,0,0] op_sel_hi:[1,1,1] neg_lo:[0,0,1] neg_hi:[0,0,1]
    v_cvt_pk_bf16_f32 v128, v4, v6
    v_pk_fma_f32 v[56:57], v[8:9], v[6:7], v[4:5] op_sel:[0,0,0] op_sel_hi:[0,1,1] neg_lo:[0,0,1] neg_hi:[0,0,1]
    v_cvt_pk_bf16_f32 v132, v5, v7
    v_pk_fma_f32 v[58:59], v[8:9], v[56:57], v[6:7] op_sel:[0,0,0] op_sel_hi:[0,1,1] neg_lo:[0,0,1] neg_hi:[0,0,1]
    v_pk_fma_f32 v[60:61], v[8:9], v[58:59], v[56:57] op_sel:[0,0,0] op_sel_hi:[0,1,1] neg_lo:[0,0,1] neg_hi:[0,0,1]
    v_cvt_pk_bf16_f32 v129, v56, v58
    v_pk_fma_f32 v[62:63], v[8:9], v[60:61], v[58:59] op_sel:[0,0,0] op_sel_hi:[0,1,1] neg_lo:[0,0,1] neg_hi:[0,0,1]
    v_cvt_pk_bf16_f32 v133, v57, v59
    v_pk_fma_f32 v[64:65], v[8:9], v[62:63], v[60:61] op_sel:[0,0,0] op_sel_hi:[0,1,1] neg_lo:[0,0,1] neg_hi:[0,0,1]
    v_cvt_pk_bf16_f32 v130, v60, v62
    v_pk_fma_f32 v[66:67], v[8:9], v[64:65], v[62:63] op_sel:[0,0,0] op_sel_hi:[0,1,1] neg_lo:[0,0,1] neg_hi:[0,0,1]
    v_cvt_pk_bf16_f32 v134, v61, v63
    v_cvt_pk_bf16_f32 v131, v64, v66
    v_cvt_pk_bf16_f32 v135, v65, v67
    s_cmp_eq_u32 s71, 0
    s_cbranch_scc1 L_pf_42
    buffer_load_dword v21, v20, s[20:23], s18 offen
    s_add_u32 s18, s18, s19
    s_sub_u32 s71, s71, 1
L_pf_42:
    s_cmp_eq_u32 s71, 0
    s_cbranch_scc1 L_pf_43
    buffer_load_dword v21, v20, s[20:23], s18 offen
    s_add_u32 s18, s18, s19
    s_sub_u32 s71, s71, 1
L_pf_43:
    v_lshl_add_u32 v1, v14, 2, s61
    v_cvt_f32_u32 v1, v1
    v_mul_f32 v1, 0x3acccccd, v1
    v_mul_f32 v2, v1, v22
    v_mul_f32 v9, 0x42000000, v1
    v_cos_f32 v8, v1
    v_cos_f32 v9, v9
    v_fmamk_f32 v3, v1, 0x0, v2
    v_fmamk_f32 v56, v1, 0x3f800000, v2
    v_cos_f32 v4, v3
    v_cos_f32 v6, v56
    v_sin_f32 v5, -v3
    v_sin_f32 v7, -v56
    v_add_f32 v8, v8, v8
    v_add_f32 v9, v9, v9
    v_cvt_pk_bf16_f32 v136, v4, v6
    v_pk_fma_f32 v[56:57], v[8:9], v[6:7], v[4:5] op_sel:[0,0,0] op_sel_hi:[0,1,1] neg_lo:[0,0,1] neg_hi:[0,0,1]
    v_cvt_pk_bf16_f32 v140, v5, v7
    v_pk_fma_f32 v[58:59], v[8:9], v[56:57], v[6:7] op_sel:[0,0,0] op_sel_hi:[0,1,1] neg_lo:[0,0,1] neg_hi:[0,0,1]
    v_pk_fma_f32 v[60:61], v[8:9], v[58:59], v[56:57] op_sel:[0,0,0] op_sel_hi:[0,1,1] neg_lo:[0,0,1] neg_hi:[0,0,1]
    v_cvt_pk_bf16_f32 v137, v56, v58
    v_pk_fma_f32 v[62:63], v[8:9], v[60:61], v[58:59] op_sel:[0,0,0] op_sel_hi:[0,1,1] neg_lo:[0,0,1] neg_hi:[0,0,1]
    v_cvt_pk_bf16_f32 v141, v57, v59
    v_pk_fma_f32 v[64:65], v[8:9], v[62:63], v[60:61] op_sel:[0,0,0] op_sel_hi:[0,1,1] neg_lo:[0,0,1] neg_hi:[0,0,1]
    v_cvt_pk_bf16_f32 v138, v60, v62
    v_pk_fma_f32 v[66:67], v[8:9], v[64:65], v[62:63] op_sel:[0,0,0] op_sel_hi:[0,1,1] neg_lo:[0,0,1] neg_hi:[0,0,1]
    v_cvt_pk_bf16_f32 v142, v61, v63
    v_cvt_pk_bf16_f32 v139, v64, v66
    v_cvt_pk_bf16_f32 v143, v65, v67
    v_fmamk_f32 v3, v1, 0x42000000, v2
    v_fmamk_f32 v56, v1, 0x42040000, v2
    v_cos_f32 v16, v3
    v_cos_f32 v18, v56
    v_sin_f32 v17, -v3
    v_sin_f32 v19, -v56
    v_cvt_pk_bf16_f32 v144, v16, v18
    v_pk_fma_f32 v[56:57], v[8:9], v[18:19], v[16:17] op_sel:[0,0,0] op_sel_hi:[0,1,1] neg_lo:[0,0,1] neg_hi:[0,0,1]
    v_cvt_pk_bf16_f32 v148, v17, v19
    v_pk_fma_f32 v[58:59], v[8:9], v[56:57], v[18:19] op_sel:[0,0,0] op_sel_hi:[0,1,1] neg_lo:[0,0,1] neg_hi:[0,0,1]
    v_pk_fma_f32 v[60:61], v[8:9], v[58:59], v[56:57] op_sel:[0,0,0] op_sel_hi:[0,1,1] neg_lo:[0,0,1] neg_hi:[0,0,1]
    v_cvt_pk_bf16_f32 v145, v56, v58
    v_pk_fma_f32 v[62:63], v[8:9], v[60:61], v[58:59] op_sel:[0,0,0] op_sel_hi:[0,1,1] neg_lo:[0,0,1] neg_hi:[0,0,1]
    v_cvt_pk_bf16_f32 v149, v57, v59
    v_pk_fma_f32 v[64:65], v[8:9], v[62:63], v[60:61] op_sel:[0,0,0] op_sel_hi:[0,1,1] neg_lo:[0,0,1] neg_hi:[0,0,1]
    v_cvt_pk_bf16_f32 v146, v60, v62
    v_pk_fma_f32 v[66:67], v[8:9], v[64:65], v[62:63] op_sel:[0,0,0] op_sel_hi:[0,1,1] neg_lo:[0,0,1] neg_hi:[0,0,1]
    v_cvt_pk_bf16_f32 v150, v61, v63
    v_cvt_pk_bf16_f32 v147, v64, v66
    v_cvt_pk_bf16_f32 v151, v65, v67
    v_pk_fma_f32 v[4:5], v[8:9], v[16:17], v[4:5] op_sel:[1,0,0] op_sel_hi:[1,1,1] neg_lo:[0,0,1] neg_hi:[0,0,1]
    v_pk_fma_f32 v[6:7], v[8:9], v[18:19], v[6:7] op_sel:[1,0,0] op_sel_hi:[1,1,1] neg_lo:[0,0,1] neg_hi:[0,0,1]
    v_cvt_pk_bf16_f32 v152, v4, v6
    v_pk_fma_f32 v[56:57], v[8:9], v[6:7], v[4:5] op_sel:[0,0,0] op_sel_hi:[0,1,1] neg_lo:[0,0,1] neg_hi:[0,0,1]
    v_cvt_pk_bf16_f32 v156, v5, v7
    v_pk_fma_f32 v[58:59], v[8:9], v[56:57], v[6:7] op_sel:[0,0,0] op_sel_hi:[0,1,1] neg_lo:[0,0,1] neg_hi:[0,0,1]
    v_pk_fma_f32 v[60:61], v[8:9], v[58:59], v[56:57] op_sel:[0,0,0] op_sel_hi:[0,1,1] neg_lo:[0,0,1] neg_hi:[0,0,1]
    v_cvt_pk_bf16_f32 v153, v56, v58
    v_pk_fma_f32 v[62:63], v[8:9], v[60:61], v[58:59] op_sel:[0,0,0] op_sel_hi:[0,1,1] neg_lo:[0,0,1] neg_hi:[0,0,1]
    v_cvt_pk_bf16_f32 v157, v57, v59
    v_pk_fma_f32 v[64:65], v[8:9], v[62:63], v[60:61] op_sel:[0,0,0] op_sel_hi:[0,1,1] neg_lo:[0,0,1] neg_hi:[0,0,1]
    v_cvt_pk_bf16_f32 v154, v60, v62
    v_pk_fma_f32 v[66:67], v[8:9], v[64:65], v[62:63] op_sel:[0,0,0] op_sel_hi:[0,1,1] neg_lo:[0,0,1] neg_hi:[0,0,1]
    v_cvt_pk_bf16_f32 v158, v61, v63
    v_cvt_pk_bf16_f32 v155, v64, v66
    v_cvt_pk_bf16_f32 v159, v65, v67
    v_pk_fma_f32 v[16:17], v[8:9], v[4:5], v[16:17] op_sel:[1,0,0] op_sel_hi:[1,1,1] neg_lo:[0,0,1] neg_hi:[0,0,1]
    v_pk_fma_f32 v[18:19], v[8:9], v[6:7], v[18:19] op_sel:[1,0,0] op_sel_hi:[1,1,1] neg_lo:[0,0,1] neg_hi:[0,0,1]
    v_cvt_pk_bf16_f32 v160, v16, v18
    v_pk_fma_f32 v[56:57], v[8:9], v[18:19], v[16:17] op_sel:[0,0,0] op_sel_hi:[0,1,1] neg_lo:[0,0,1] neg_hi:[0,0,1]
    v_cvt_pk_bf16_f32 v164, v17, v19
    v_pk_fma_f32 v[58:59], v[8:9], v[56:57], v[18:19] op_sel:[0,0,0] op_sel_hi:[0,1,1] neg_lo:[0,0,1] neg_hi:[0,0,1]
    v_pk_fma_f32 v[60:61], v[8:9], v[58:59], v[56:57] op_sel:[0,0,0] op_sel_hi:[0,1,1] neg_lo:[0,0,1] neg_hi:[0,0,1]
    v_cvt_pk_bf16_f32 v161, v56, v58
    v_pk_fma_f32 v[62:63], v[8:9], v[60:61], v[58:59] op_sel:[0,0,0] op_sel_hi:[0,1,1] neg_lo:[0,0,1] neg_hi:[0,0,1]
    v_cvt_pk_bf16_f32 v165, v57, v59
    v_pk_fma_f32 v[64:65], v[8:9], v[62:63], v[60:61] op_sel:[0,0,0] op_sel_hi:[0,1,1] neg_lo:[0,0,1] neg_hi:[0,0,1]
    v_cvt_pk_bf16_f32 v162, v60, v62
    v_pk_fma_f32 v[66:67], v[8:9], v[64:65], v[62:63] op_sel:[0,0,0] op_sel_hi:[0,1,1] neg_lo:[0,0,1] neg_hi:[0,0,1]
    v_cvt_pk_bf16_f32 v166, v61, v63
    v_cvt_pk_bf16_f32 v163, v64, v66
    v_cvt_pk_bf16_f32 v167, v65, v67
    v_pk_fma_f32 v[4:5], v[8:9], v[16:17], v[4:5] op_sel:[1,0,0] op_sel_hi:[1,1,1] neg_lo:[0,0,1] neg_hi:[0,0,1]
    v_pk_fma_f32 v[6:7], v[8:9], v[18:19], v[6:7] op_sel:[1,0,0] op_sel_hi:[1,1,1] neg_lo:[0,0,1] neg_hi:[0,0,1]
    v_cvt_pk_bf16_f32 v168, v4, v6
    v_pk_fma_f32 v[56:57], v[8:9], v[6:7], v[4:5] op_sel:[0,0,0] op_sel_hi:[0,1,1] neg_lo:[0,0,1] neg_hi:[0,0,1]
    v_cvt_pk_bf16_f32 v172, v5, v7
    v_pk_fma_f32 v[58:59], v[8:9], v[56:57], v[6:7] op_sel:[0,0,0] op_sel_hi:[0,1,1] neg_lo:[0,0,1] neg_hi:[0,0,1]
    v_pk_fma_f32 v[60:61], v[8:9], v[58:59], v[56:57] op_sel:[0,0,0] op_sel_hi:[0,1,1] neg_lo:[0,0,1] neg_hi:[0,0,1]
    v_cvt_pk_bf16_f32 v169, v56, v58
    v_pk_fma_f32 v[62:63], v[8:9], v[60:61], v[58:59] op_sel:[0,0,0] op_sel_hi:[0,1,1] neg_lo:[0,0,1] neg_hi:[0,0,1]
    v_cvt_pk_bf16_f32 v173, v57, v59
    v_pk_fma_f32 v[64:65], v[8:9], v[62:63], v[60:61] op_sel:[0,0,0] op_sel_hi:[0,1,1] neg_lo:[0,0,1] neg_hi:[0,0,1]
    v_cvt_pk_bf16_f32 v170, v60, v62
    v_pk_fma_f32 v[66:67], v[8:9], v[64:65], v[62:63] op_sel:[0,0,0] op_sel_hi:[0,1,1] neg_lo:[0,0,1] neg_hi:[0,0,1]
    v_cvt_pk_bf16_f32 v174, v61, v63
    v_cvt_pk_bf16_f32 v171, v64, v66
    v_cvt_pk_bf16_f32 v175, v65, v67
    s_cmp_eq_u32 s71, 0
    s_cbranch_scc1 L_pf_44
    buffer_load_dword v21, v20, s[20:23], s18 offen
    s_add_u32 s18, s18, s19
    s_sub_u32 s71, s71, 1
L_pf_44:
    s_cmp_eq_u32 s71, 0
    s_cbranch_scc1 L_pf_45
    buffer_load_dword v21, v20, s[20:23], s18 offen
    s_add_u32 s18, s18, s19
    s_sub_u32 s71, s71, 1
L_pf_45:
    s_cmp_le_u32 s68, 2
    s_cbranch_scc1 L_B_gen
    v_lshl_add_u32 v1, v14, 2, s62
    v_cvt_f32_u32 v1, v1
    v_mul_f32 v1, 0x3acccccd, v1
    v_mul_f32 v2, v1, v22
    v_mul_f32 v9, 0x42000000, v1
    v_cos_f32 v8, v1
    v_cos_f32 v9, v9
    v_fmamk_f32 v3, v1, 0x0, v2
    v_fmamk_f32 v56, v1, 0x3f800000, v2
    v_cos_f32 v4, v3
    v_cos_f32 v6, v56
    v_sin_f32 v5, -v3
    v_sin_f32 v7, -v56
    v_add_f32 v8, v8, v8
    v_add_f32 v9, v9, v9
    v_cvt_pk_bf16_f32 v176, v4, v6
    v_pk_fma_f32 v[56:57], v[8:9], v[6:7], v[4:5] op_sel:[0,0,0] op_sel_hi:[0,1,1] neg_lo:[0,0,1] neg_hi:[0,0,1]
    v_cvt_pk_bf16_f32 v180, v5, v7
    v_pk_fma_f32 v[58:59], v[8:9], v[56:57], v[6:7] op_sel:[0,0,0] op_sel_hi:[0,1,1] neg_lo:[0,0,1] neg_hi:[0,0,1]
    v_pk_fma_f32 v[60:61], v[8:9], v[58:59], v[56:57] op_sel:[0,0,0] op_sel_hi:[0,1,1] neg_lo:[0,0,1] neg_hi:[0,0,1]
    v_cvt_pk_bf16_f32 v177, v56, v58
    v_pk_fma_f32 v[62:63], v[8:9], v[60:61], v[58:59] op_sel:[0,0,0] op_sel_hi:[0,1,1] neg_lo:[0,0,1] neg_hi:[0,0,1]
    v_cvt_pk_bf16_f32 v181, v57, v59
    v_pk_fma_f32 v[64:65], v[8:9], v[62:63], v[60:61] op_sel:[0,0,0] op_sel_hi:[0,1,1] neg_lo:[0,0,1] neg_hi:[0,0,1]
    v_cvt_pk_bf16_f32 v178, v60, v62
    v_pk_fma_f32 v[66:67], v[8:9], v[64:65], v[62:63] op_sel:[0,0,0] op_sel_hi:[0,1,1] neg_lo:[0,0,1] neg_hi:[0,0,1]
    v_cvt_pk_bf16_f32 v182, v61, v63
    v_cvt_pk_bf16_f32 v179, v64, v66
    v_cvt_pk_bf16_f32 v183, v65, v67
    v_fmamk_f32 v3, v1, 0x42000000, v2
    v_fmamk_f32 v56, v1, 0x42040000, v2
    v_cos_f32 v16, v3
    v_cos_f32 v18, v56
    v_sin_f32 v17, -v3
    v_sin_f32 v19, -v56
    v_cvt_pk_bf16_f32 v184, v16, v18
    v_pk_fma_f32 v[56:57], v[8:9], v[18:19], v[16:17] op_sel:[0,0,0] op_sel_hi:[0,1,1] neg_lo:[0,0,1] neg_hi:[0,0,1]
    v_cvt_pk_bf16_f32 v188, v17, v19
    v_pk_fma_f32 v[58:59], v[8:9], v[56:57], v[18:19] op_sel:[0,0,0] op_sel_hi:[0,1,1] neg_lo:[0,0,1] neg_hi:[0,0,1]
    v_pk_fma_f32 v[60:61], v[8:9], v[58:59], v[56:57] op_sel:[0,0,0] op_sel_hi:[0,1,1] neg_lo:[0,0,1] neg_hi:[0,0,1]
    v_cvt_pk_bf16_f32 v185, v56, v58
    v_pk_fma_f32 v[62:63], v[8:9], v[60:61], v[58:59] op_sel:[0,0,0] op_sel_hi:[0,1,1] neg_lo:[0,0,1] neg_hi:[0,0,1]
    v_cvt_pk_bf16_f32 v189, v57, v59
    v_pk_fma_f32 v[64:65], v[8:9], v[62:63], v[60:61] op_sel:[0,0,0] op_sel_hi:[0,1,1] neg_lo:[0,0,1] neg_hi:[0,0,1]
    v_cvt_pk_bf16_f32 v186, v60, v62
    v_pk_fma_f32 v[66:67], v[8:9], v[64:65], v[62:63] op_sel:[0,0,0] op_sel_hi:[0,1,1] neg_lo:[0,0,1] neg_hi:[0,0,1]
    v_cvt_pk_bf16_f32 v190, v61, v63
    v_cvt_pk_bf16_f32 v187, v64, v66
    v_cvt_pk_bf16_f32 v191, v65, v67
    v_pk_fma_f32 v[4:5], v[8:9], v[16:17], v[4:5] op_sel:[1,0,0] op_sel_hi:[1,1,1] neg_lo:[0,0,1] neg_hi:[0,0,1]
    v_pk_fma_f32 v[6:7], v[8:9], v[18:19], v[6:7] op_sel:[1,0,0] op_sel_hi:[1,1,1] neg_lo:[0,0,1] neg_hi:[0,0,1]
    v_cvt_pk_bf16_f32 v192, v4, v6
    v_pk_fma_f32 v[56:57], v[8:9], v[6:7], v[4:5] op_sel:[0,0,0] op_sel_hi:[0,1,1] neg_lo:[0,0,1] neg_hi:[0,0,1]
    v_cvt_pk_bf16_f32 v196, v5, v7
    v_pk_fma_f32 v[58:59], v[8:9], v[56:57], v[6:7] op_sel:[0,0,0] op_sel_hi:[0,1,1] neg_lo:[0,0,1] neg_hi:[0,0,1]
    v_pk_fma_f32 v[60:61], v[8:9], v[58:59], v[56:57] op_sel:[0,0,0] op_sel_hi:[0,1,1] neg_lo:[0,0,1] neg_hi:[0,0,1]
    v_cvt_pk_bf16_f32 v193, v56, v58
    v_pk_fma_f32 v[62:63], v[8:9], v[60:61], v[58:59] op_sel:[0,0,0] op_sel_hi:[0,1,1] neg_lo:[0,0,1] neg_hi:[0,0,1]
    v_cvt_pk_bf16_f32 v197, v57, v59
    v_pk_fma_f32 v[64:65], v[8:9], v[62:63], v[60:61] op_sel:[0,0,0] op_sel_hi:[0,1,1] neg_lo:[0,0,1] neg_hi:[0,0,1]
    v_cvt_pk_bf16_f32 v194, v60, v62
    v_pk_fma_f32 v[66:67], v[8:9], v[64:65], v[62:63] op_sel:[0,0,0] op_sel_hi:[0,1,1] neg_lo:[0,0,1] neg_hi:[0,0,1]
    v_cvt_pk_bf16_f32 v198, v61, v63
    v_cvt_pk_bf16_f32 v195, v64, v66
    v_cvt_pk_bf16_f32 v199, v65, v67
    v_pk_fma_f32 v[16:17], v[8:9], v[4:5], v[16:17] op_sel:[1,0,0] op_sel_hi:[1,1,1] neg_lo:[0,0,1] neg_hi:[0,0,1]
    v_pk_fma_f32 v[18:19], v[8:9], v[6:7], v[18:19] op_sel:[1,0,0] op_sel_hi:[1,1,1] neg_lo:[0,0,1] neg_hi:[0,0,1]
    v_cvt_pk_bf16_f32 v200, v16, v18
    v_pk_fma_f32 v[56:57], v[8:9], v[18:19], v[16:17] op_sel:[0,0,0] op_sel_hi:[0,1,1] neg_lo:[0,0,1] neg_hi:[0,0,1]
    v_cvt_pk_bf16_f32 v204, v17, v19
    v_pk_fma_f32 v[58:59], v[8:9], v[56:57], v[18:19] op_sel:[0,0,0] op_sel_hi:[0,1,1] neg_lo:[0,0,1] neg_hi:[0,0,1]
    v_pk_fma_f32 v[60:61], v[8:9], v[58:59], v[56:57] op_sel:[0,0,0] op_sel_hi:[0,1,1] neg_lo:[0,0,1] neg_hi:[0,0,1]
    v_cvt_pk_bf16_f32 v201, v56, v58
    v_pk_fma_f32 v[62:63], v[8:9], v[60:61], v[58:59] op_sel:[0,0,0] op_sel_hi:[0,1,1] neg_lo:[0,0,1] neg_hi:[0,0,1]
    v_cvt_pk_bf16_f32 v205, v57, v59
    v_pk_fma_f32 v[64:65], v[8:9], v[62:63], v[60:61] op_sel:[0,0,0] op_sel_hi:[0,1,1] neg_lo:[0,0,1] neg_hi:[0,0,1]
    v_cvt_pk_bf16_f32 v202, v60, v62
    v_pk_fma_f32 v[66:67], v[8:9], v[64:65], v[62:63] op_sel:[0,0,0] op_sel_hi:[0,1,1] neg_lo:[0,0,1] neg_hi:[0,0,1]
    v_cvt_pk_bf16_f32 v206, v61, v63
    v_cvt_pk_bf16_f32 v203, v64, v66
    v_cvt_pk_bf16_f32 v207, v65, v67
    v_pk_fma_f32 v[4:5], v[8:9], v[16:17], v[4:5] op_sel:[1,0,0] op_sel_hi:[1,1,1] neg_lo:[0,0,1] neg_hi:[0,0,1]
    v_pk_fma_f32 v[6:7], v[8:9], v[18:19], v[6:7] op_sel:[1,0,0] op_sel_hi:[1,1,1] neg_lo:[0,0,1] neg_hi:[0,0,1]
    v_cvt_pk_bf16_f32 v208, v4, v6
    v_pk_fma_f32 v[56:57], v[8:9], v[6:7], v[4:5] op_sel:[0,0,0] op_sel_hi:[0,1,1] neg_lo:[0,0,1] neg_hi:[0,0,1]
    v_cvt_pk_bf16_f32 v212, v5, v7
    v_pk_fma_f32 v[58:59], v[8:9], v[56:57], v[6:7] op_sel:[0,0,0] op_sel_hi:[0,1,1] neg_lo:[0,0,1] neg_hi:[0,0,1]
    v_pk_fma_f32 v[60:61], v[8:9], v[58:59], v[56:57] op_sel:[0,0,0] op_sel_hi:[0,1,1] neg_lo:[0,0,1] neg_hi:[0,0,1]
    v_cvt_pk_bf16_f32 v209, v56, v58
    v_pk_fma_f32 v[62:63], v[8:9], v[60:61], v[58:59] op_sel:[0,0,0] op_sel_hi:[0,1,1] neg_lo:[0,0,1] neg_hi:[0,0,1]
    v_cvt_pk_bf16_f32 v213, v57, v59
    v_pk_fma_f32 v[64:65], v[8:9], v[62:63], v[60:61] op_sel:[0,0,0] op_sel_hi:[0,1,1] neg_lo:[0,0,1] neg_hi:[0,0,1]
    v_cvt_pk_bf16_f32 v210, v60, v62
    v_pk_fma_f32 v[66:67], v[8:9], v[64:65], v[62:63] op_sel:[0,0,0] op_sel_hi:[0,1,1] neg_lo:[0,0,1] neg_hi:[0,0,1]
    v_cvt_pk_bf16_f32 v214, v61, v63
    v_cvt_pk_bf16_f32 v211, v64, v66
    v_cvt_pk_bf16_f32 v215, v65, v67
L_B_gen:
    v_lshl_add_u32 v1, v15, 8, s57
    v_cvt_f32_u32 v1, v1
    v_add_u32 v2, 0, v14
    v_cvt_f32_u32 v2, v2
    v_mul_f32 v2, 0x3a000000, v2
    v_mul_f32 v9, v2, v1
    v_fmamk_f32 v3, v2, 0x0, v9
    v_fmamk_f32 v4, v2, 0x42800000, v9
    v_cos_f32 v5, v3
    v_cos_f32 v6, v4
    v_sin_f32 v7, v3
    v_sin_f32 v8, v4
    v_cvt_pk_bf16_f32 v72, v5, v6
    v_cvt_pk_bf16_f32 v76, v7, v8
    v_xor_b32 v80, 0x80008000, v76
    v_fmamk_f32 v3, v2, 0x43000000, v9
    v_fmamk_f32 v4, v2, 0x43400000, v9
    v_cos_f32 v5, v3
    v_cos_f32 v6, v4
    v_sin_f32 v7, v3
    v_sin_f32 v8, v4
    v_cvt_pk_bf16_f32 v73, v5, v6
    v_cvt_pk_bf16_f32 v77, v7, v8
    v_xor_b32 v81, 0x80008000, v77
    v_fmamk_f32 v3, v2, 0x44800000, v9
    v_fmamk_f32 v4, v2, 0x44880000, v9
    v_cos_f32 v5, v3
    v_cos_f32 v6, v4
    v_sin_f32 v7, v3
    v_sin_f32 v8, v4
    v_cvt_pk_bf16_f32 v74, v5, v6
    v_cvt_pk_bf16_f32 v78, v7, v8
    v_xor_b32 v82, 0x80008000, v78
    v_fmamk_f32 v3, v2, 0x44900000, v9
    v_fmamk_f32 v4, v2, 0x44980000, v9
    v_cos_f32 v5, v3
    v_cos_f32 v6, v4
    v_sin_f32 v7, v3
    v_sin_f32 v8, v4
    v_cvt_pk_bf16_f32 v75, v5, v6
    v_cvt_pk_bf16_f32 v79, v7, v8
    v_xor_b32 v83, 0x80008000, v79
    v_add_u32 v2, 16, v14
    v_cvt_f32_u32 v2, v2
    v_mul_f32 v2, 0x3a000000, v2
    v_mul_f32 v9, v2, v1
    v_fmamk_f32 v3, v2, 0x0, v9
    v_fmamk_f32 v4, v2, 0x42800000, v9
    v_cos_f32 v5, v3
    v_cos_f32 v6, v4
    v_sin_f32 v7, v3
    v_sin_f32 v8, v4
    v_cvt_pk_bf16_f32 v84, v5, v6
    v_cvt_pk_bf16_f32 v88, v7, v8
    v_xor_b32 v92, 0x80008000, v88
    v_fmamk_f32 v3, v2, 0x43000000, v9
    v_fmamk_f32 v4, v2, 0x43400000, v9
    v_cos_f32 v5, v3
    v_cos_f32 v6, v4
    v_sin_f32 v7, v3
    v_sin_f32 v8, v4
    v_cvt_pk_bf16_f32 v85, v5, v6
    v_cvt_pk_bf16_f32 v89, v7, v8
    v_xor_b32 v93, 0x80008000, v89
    v_fmamk_f32 v3, v2, 0x44800000, v9
    v_fmamk_f32 v4, v2, 0x44880000, v9
    v_cos_f32 v5, v3
    v_cos_f32 v6, v4
    v_sin_f32 v7, v3
    v_sin_f32 v8, v4
    v_cvt_pk_bf16_f32 v86, v5, v6
    v_cvt_pk_bf16_f32 v90, v7, v8
    v_xor_b32 v94, 0x80008000, v90
    v_fmamk_f32 v3, v2, 0x44900000, v9
    v_fmamk_f32 v4, v2, 0x44980000, v9
    v_cos_f32 v5, v3
    v_cos_f32 v6, v4
    v_sin_f32 v7, v3
    v_sin_f32 v8, v4
    v_cvt_pk_bf16_f32 v87, v5, v6
    v_cvt_pk_bf16_f32 v91, v7, v8
    v_xor_b32 v95, 0x80008000, v91
    s_cmp_eq_u32 s71, 0
    s_cbranch_scc1 L_pf_46
    buffer_load_dword v21, v20, s[20:23], s18 offen
    s_add_u32 s18, s18, s19
    s_sub_u32 s71, s71, 1
L_pf_46:
    s_cmp_ge_u32 s48, 3
    s_cbranch_scc1 L_B_w0
    s_waitcnt vmcnt(5)
    s_branch L_B_w1
L_B_w0:
    s_waitcnt vmcnt(0)
L_B_w1:
    s_cmp_lg_u32 s70, 0
    s_cbranch_scc1 L_B_noclr2
    v_mov_b32 v1, 0
    v_mov_b32 v2, 1
    s_mov_b64 exec, 1
    buffer_store_dword v2, v1, s[40:43], 0 offen sc1
    s_mov_b64 exec, -1
L_B_noclr2:
    v_lshlrev_b32 v2, 16, v24
    v_and_b32 v3, 0xffff0000, v24
    v_lshlrev_b32 v4, 16, v28
    v_and_b32 v5, 0xffff0000, v28
    v_lshlrev_b32 v6, 16, v32
    v_and_b32 v7, 0xffff0000, v32
    v_lshlrev_b32 v8, 16, v36
    v_and_b32 v9, 0xffff0000, v36
    v_pk_add_f32 v[16:17], v[2:3], v[6:7]
    v_pk_add_f32 v[2:3], v[2:3], v[6:7] neg_lo:[0,1] neg_hi:[0,1]
    v_pk_add_f32 v[18:19], v[4:5], v[8:9]
    v_pk_add_f32 v[4:5], v[4:5], v[8:9] neg_lo:[0,1] neg_hi:[0,1]
    v_pk_add_f32 v[6:7], v[16:17], v[18:19]
    v_pk_add_f32 v[8:9], v[16:17], v[18:19] neg_lo:[0,1] neg_hi:[0,1]
    v_cvt_pk_bf16_f32 v64, v2, v3
    v_cvt_pk_bf16_f32 v68, v4, v5
    v_cvt_pk_bf16_f32 v56, v6, v7
    v_cvt_pk_bf16_f32 v60, v8, v9
    v_lshlrev_b32 v2, 16, v25
    v_and_b32 v3, 0xffff0000, v25
    v_lshlrev_b32 v4, 16, v29
    v_and_b32 v5, 0xffff0000, v29
    v_lshlrev_b32 v6, 16, v33
    v_and_b32 v7, 0xffff0000, v33
    v_lshlrev_b32 v8, 16, v37
    v_and_b32 v9, 0xffff0000, v37
    v_pk_add_f32 v[16:17], v[2:3], v[6:7]
    v_pk_add_f32 v[2:3], v[2:3], v[6:7] neg_lo:[0,1] neg_hi:[0,1]
    v_pk_add_f32 v[18:19], v[4:5], v[8:9]
    v_pk_add_f32 v[4:5], v[4:5], v[8:9] neg_lo:[0,1] neg_hi:[0,1]
    v_pk_add_f32 v[6:7], v[16:17], v[18:19]
    v_pk_add_f32 v[8:9], v[16:17], v[18:19] neg_lo:[0,1] neg_hi:[0,1]
    v_cvt_pk_bf16_f32 v65, v2, v3
    v_cvt_pk_bf16_f32 v69, v4, v5
    v_cvt_pk_bf16_f32 v57, v6, v7
    v_cvt_pk_bf16_f32 v61, v8, v9
    v_lshlrev_b32 v2, 16, v26
    v_and_b32 v3, 0xffff0000, v26
    v_lshlrev_b32 v4, 16, v30
    v_and_b32 v5, 0xffff0000, v30
    v_lshlrev_b32 v6, 16, v34
    v_and_b32 v7, 0xffff0000, v34
    v_lshlrev_b32 v8, 16, v38
    v_and_b32 v9, 0xffff0000, v38
    v_pk_add_f32 v[16:17], v[2:3], v[6:7]
    v_pk_add_f32 v[2:3], v[2:3], v[6:7] neg_lo:[0,1] neg_hi:[0,1]
    v_pk_add_f32 v[18:19], v[4:5], v[8:9]
    v_pk_add_f32 v[4:5], v[4:5], v[8:9] neg_lo:[0,1] neg_hi:[0,1]
    v_pk_add_f32 v[6:7], v[16:17], v[18:19]
    v_pk_add_f32 v[8:9], v[16:17], v[18:19] neg_lo:[0,1] neg_hi:[0,1]
    v_cvt_pk_bf16_f32 v66, v2, v3
    v_cvt_pk_bf16_f32 v70, v4, v5
    v_cvt_pk_bf16_f32 v58, v6, v7
    v_cvt_pk_bf16_f32 v62, v8, v9
    v_lshlrev_b32 v2, 16, v27
    v_and_b32 v3, 0xffff0000, v27
    v_lshlrev_b32 v4, 16, v31
    v_and_b32 v5, 0xffff0000, v31
    v_lshlrev_b32 v6, 16, v35
    v_and_b32 v7, 0xffff0000, v35
    v_lshlrev_b32 v8, 16, v39
    v_and_b32 v9, 0xffff0000, v39
    v_pk_add_f32 v[16:17], v[2:3], v[6:7]
    v_pk_add_f32 v[2:3], v[2:3], v[6:7] neg_lo:[0,1] neg_hi:[0,1]
    v_pk_add_f32 v[18:19], v[4:5], v[8:9]
    v_pk_add_f32 v[4:5], v[4:5], v[8:9] neg_lo:[0,1] neg_hi:[0,1]
    v_pk_add_f32 v[6:7], v[16:17], v[18:19]
    v_pk_add_f32 v[8:9], v[16:17], v[18:19] neg_lo:[0,1] neg_hi:[0,1]
    v_cvt_pk_bf16_f32 v67, v2, v3
    v_cvt_pk_bf16_f32 v71, v4, v5
    v_cvt_pk_bf16_f32 v59, v6, v7
    v_cvt_pk_bf16_f32 v63, v8, v9
    ds_write_b128 v12, v[56:59] offset:0
    ds_write_b128 v12, v[60:63] offset:10240
    ds_write_b128 v12, v[64:67] offset:20480
    ds_write_b128 v12, v[68:71] offset:30720
    s_sub_u32 s59, s48, 2
    s_cmp_ge_u32 s59, 2
    s_cbranch_scc1 L_B_f1
    s_waitcnt lgkmcnt(0)
    v_lshlrev_b32 v2, 16, v40
    v_and_b32 v3, 0xffff0000, v40
    v_lshlrev_b32 v4, 16, v44
    v_and_b32 v5, 0xffff0000, v44
    v_lshlrev_b32 v6, 16, v48
    v_and_b32 v7, 0xffff0000, v48
    v_lshlrev_b32 v8, 16, v52
    v_and_b32 v9, 0xffff0000, v52
    v_pk_add_f32 v[16:17], v[2:3], v[6:7]
    v_pk_add_f32 v[2:3], v[2:3], v[6:7] neg_lo:[0,1] neg_hi:[0,1]
    v_pk_add_f32 v[18:19], v[4:5], v[8:9]
    v_pk_add_f32 v[4:5], v[4:5], v[8:9] neg_lo:[0,1] neg_hi:[0,1]
    v_pk_add_f32 v[6:7], v[16:17], v[18:19]
    v_pk_add_f32 v[8:9], v[16:17], v[18:19] neg_lo:[0,1] neg_hi:[0,1]
    v_cvt_pk_bf16_f32 v64, v2, v3
    v_cvt_pk_bf16_f32 v68, v4, v5
    v_cvt_pk_bf16_f32 v56, v6, v7
    v_cvt_pk_bf16_f32 v60, v8, v9
    v_lshlrev_b32 v2, 16, v41
    v_and_b32 v3, 0xffff0000, v41
    v_lshlrev_b32 v4, 16, v45
    v_and_b32 v5, 0xffff0000, v45
    v_lshlrev_b32 v6, 16, v49
    v_and_b32 v7, 0xffff0000, v49
    v_lshlrev_b32 v8, 16, v53
    v_and_b32 v9, 0xffff0000, v53
    v_pk_add_f32 v[16:17], v[2:3], v[6:7]
    v_pk_add_f32 v[2:3], v[2:3], v[6:7] neg_lo:[0,1] neg_hi:[0,1]
    v_pk_add_f32 v[18:19], v[4:5], v[8:9]
    v_pk_add_f32 v[4:5], v[4:5], v[8:9] neg_lo:[0,1] neg_hi:[0,1]
    v_pk_add_f32 v[6:7], v[16:17], v[18:19]
    v_pk_add_f32 v[8:9], v[16:17], v[18:19] neg_lo:[0,1] neg_hi:[0,1]
    v_cvt_pk_bf16_f32 v65, v2, v3
    v_cvt_pk_bf16_f32 v69, v4, v5
    v_cvt_pk_bf16_f32 v57, v6, v7
    v_cvt_pk_bf16_f32 v61, v8, v9
    v_lshlrev_b32 v2, 16, v42
    v_and_b32 v3, 0xffff0000, v42
    v_lshlrev_b32 v4, 16, v46
    v_and_b32 v5, 0xffff0000, v46
    v_lshlrev_b32 v6, 16, v50
    v_and_b32 v7, 0xffff0000, v50
    v_lshlrev_b32 v8, 16, v54
    v_and_b32 v9, 0xffff0000, v54
    v_pk_add_f32 v[16:17], v[2:3], v[6:7]
    v_pk_add_f32 v[2:3], v[2:3], v[6:7] neg_lo:[0,1] neg_hi:[0,1]
    v_pk_add_f32 v[18:19], v[4:5], v[8:9]
    v_pk_add_f32 v[4:5], v[4:5], v[8:9] neg_lo:[0,1] neg_hi:[0,1]
    v_pk_add_f32 v[6:7], v[16:17], v[18:19]
    v_pk_add_f32 v[8:9], v[16:17], v[18:19] neg_lo:[0,1] neg_hi:[0,1]
    v_cvt_pk_bf16_f32 v66, v2, v3
    v_cvt_pk_bf16_f32 v70, v4, v5
    v_cvt_pk_bf16_f32 v58, v6, v7
    v_cvt_pk_bf16_f32 v62, v8, v9
    v_lshlrev_b32 v2, 16, v43
    v_and_b32 v3, 0xffff0000, v43
    v_lshlrev_b32 v4, 16, v47
    v_and_b32 v5, 0xffff0000, v47
    v_lshlrev_b32 v6, 16, v51
    v_and_b32 v7, 0xffff0000, v51
    v_lshlrev_b32 v8, 16, v55
    v_and_b32 v9, 0xffff0000, v55
    v_pk_add_f32 v[16:17], v[2:3], v[6:7]
    v_pk_add_f32 v[2:3], v[2:3], v[6:7] neg_lo:[0,1] neg_hi:[0,1]
    v_pk_add_f32 v[18:19], v[4:5], v[8:9]
    v_pk_add_f32 v[4:5], v[4:5], v[8:9] neg_lo:[0,1] neg_hi:[0,1]
    v_pk_add_f32 v[6:7], v[16:17], v[18:19]
    v_pk_add_f32 v[8:9], v[16:17], v[18:19] neg_lo:[0,1] neg_hi:[0,1]
    v_cvt_pk_bf16_f32 v67, v2, v3
    v_cvt_pk_bf16_f32 v71, v4, v5
    v_cvt_pk_bf16_f32 v59, v6, v7
    v_cvt_pk_bf16_f32 v63, v8, v9
    ds_write_b128 v13, v[56:59] offset:0
    ds_write_b128 v13, v[60:63] offset:10240
    ds_write_b128 v13, v[64:67] offset:20480
    ds_write_b128 v13, v[68:71] offset:30720
L_B_f1:
    s_cmp_eq_u32 s71, 0
    s_cbranch_scc1 L_pf_47
    buffer_load_dword v21, v20, s[20:23], s18 offen
    s_add_u32 s18, s18, s19
    s_sub_u32 s71, s71, 1
L_pf_47:
    v_xor_b32 v1, v14, v15
    v_lshlrev_b32 v1, 4, v1
    v_lshl_add_u32 v1, v15, 8, v1
    v_add_u32 v10, 106496, v1
    v_xor_b32 v11, 192, v10
    s_mul_i32 s58, s57, 51200
    s_add_u32 s58, s58, 2621440
    v_lshl_add_u32 v12, v0, 4, s58
    s_lshl_b32 s58, s48, 11
    v_bfe_u32 v1, v14, 1, 2
    v_xor_b32 v1, v1, v15
    v_lshlrev_b32 v1, 4, v1
    v_lshl_add_u32 v1, v14, 6, v1
    v_add_u32 v13, s58, v1
    v_bfe_u32 v1, v0, 3, 2
    v_xor_b32 v1, v1, v0
    v_lshl_add_u32 v23, v1, 4, s58
    s_waitcnt lgkmcnt(0)
    s_barrier
    s_cmp_lt_u32 s48, 6
    s_cbranch_scc1 L_B_npwa
    s_lshl_b32 s58, s57, 1
    s_add_u32 s58, s58, s48
    s_sub_u32 s58, s58, 6
    s_mul_i32 s58, s58, 6400
    v_lshlrev_b32 v1, 7, v0
    s_mov_b32 exec_hi, 0x3ffff
    buffer_load_dword v21, v1, s[28:31], s58 offen
    s_mov_b32 exec_hi, -1
L_B_npwa:
    s_cmp_ge_u32 s48, 4
    s_cbranch_scc1 L_B_lu
    ds_read_b128 v[24:27], v10 offset:20480
    ds_read_b128 v[28:31], v10 offset:30720
    ds_read_b128 v[32:35], v10 offset:25600
    ds_read_b128 v[36:39], v10 offset:35840
    ds_read_b128 v[40:43], v11 offset:21504
    ds_read_b128 v[44:47], v11 offset:31744
    s_waitcnt lgkmcnt(4)
    v_mfma_f32_16x16x32_bf16 v[56:59], v[24:27], v[96:99], 0
    v_mfma_f32_16x16x32_bf16 v[64:67], v[24:27], v[100:103], 0
    v_mfma_f32_16x16x32_bf16 v[216:219], v[28:31], v[100:103], 0
    v_mfma_f32_16x16x32_bf16 v[224:227], v[28:31], v[96:99], 0
    ds_read_b128 v[24:27], v11 offset:26624
    ds_read_b128 v[28:31], v11 offset:36864
    s_waitcnt lgkmcnt(4)
    v_mfma_f32_16x16x32_bf16 v[60:63], v[32:35], v[96:99], 0
    v_mfma_f32_16x16x32_bf16 v[68:71], v[32:35], v[100:103], 0
    v_mfma_f32_16x16x32_bf16 v[220:223], v[36:39], v[100:103], 0
    v_mfma_f32_16x16x32_bf16 v[228:231], v[36:39], v[96:99], 0
    ds_read_b128 v[32:35], v10 offset:22528
    ds_read_b128 v[36:39], v10 offset:32768
    s_waitcnt lgkmcnt(4)
    v_mfma_f32_16x16x32_bf16 v[56:59], v[40:43], v[104:107], v[56:59]
    v_mfma_f32_16x16x32_bf16 v[64:67], v[40:43], v[108:111], v[64:67]
    v_mfma_f32_16x16x32_bf16 v[216:219], v[44:47], v[108:111], v[216:219]
    v_mfma_f32_16x16x32_bf16 v[224:227], v[44:47], v[104:107], v[224:227]
    ds_read_b128 v[40:43], v10 offset:27648
    ds_read_b128 v[44:47], v10 offset:37888
    s_waitcnt lgkmcnt(4)
    v_mfma_f32_16x16x32_bf16 v[60:63], v[24:27], v[104:107], v[60:63]
    v_mfma_f32_16x16x32_bf16 v[68:71], v[24:27], v[108:111], v[68:71]
    v_mfma_f32_16x16x32_bf16 v[220:223], v[28:31], v[108:111], v[220:223]
    v_mfma_f32_16x16x32_bf16 v[228:231], v[28:31], v[104:107], v[228:231]
    ds_read_b128 v[24:27], v11 offset:23552
    ds_read_b128 v[28:31], v11 offset:33792
    s_waitcnt lgkmcnt(4)
    v_mfma_f32_16x16x32_bf16 v[56:59], v[32:35], v[112:115], v[56:59]
    v_mfma_f32_16x16x32_bf16 v[64:67], v[32:35], v[116:119], v[64:67]
    v_mfma_f32_16x16x32_bf16 v[216:219], v[36:39], v[116:119], v[216:219]
    v_mfma_f32_16x16x32_bf16 v[224:227], v[36:39], v[112:115], v[224:227]
    ds_read_b128 v[32:35], v11 offset:28672
    ds_read_b128 v[36:39], v11 offset:38912
    s_waitcnt lgkmcnt(4)
    v_mfma_f32_16x16x32_bf16 v[60:63], v[40:43], v[112:115], v[60:63]
    v_mfma_f32_16x16x32_bf16 v[68:71], v[40:43], v[116:119], v[68:71]
    v_mfma_f32_16x16x32_bf16 v[220:223], v[44:47], v[116:119], v[220:223]
    v_mfma_f32_16x16x32_bf16 v[228:231], v[44:47], v[112:115], v[228:231]
    ds_read_b128 v[40:43], v10 offset:24576
    ds_read_b128 v[44:47], v10 offset:34816
    s_waitcnt lgkmcnt(4)
    v_mfma_f32_16x16x32_bf16 v[56:59], v[24:27], v[120:123], v[56:59]
    v_mfma_f32_16x16x32_bf16 v[64:67], v[24:27], v[124:127], v[64:67]
    v_mfma_f32_16x16x32_bf16 v[216:219], v[28:31], v[124:127], v[216:219]
    v_mfma_f32_16x16x32_bf16 v[224:227], v[28:31], v[120:123], v[224:227]
    ds_read_b128 v[24:27], v10 offset:29696
    ds_read_b128 v[28:31], v10 offset:39936
    s_waitcnt lgkmcnt(4)
    v_mfma_f32_16x16x32_bf16 v[60:63], v[32:35], v[120:123], v[60:63]
    v_mfma_f32_16x16x32_bf16 v[68:71], v[32:35], v[124:127], v[68:71]
    v_mfma_f32_16x16x32_bf16 v[220:223], v[36:39], v[124:127], v[220:223]
    v_mfma_f32_16x16x32_bf16 v[228:231], v[36:39], v[120:123], v[228:231]
    s_waitcnt lgkmcnt(2)
    v_mfma_f32_16x16x32_bf16 v[56:59], v[40:43], v[128:131], v[56:59]
    v_mfma_f32_16x16x32_bf16 v[64:67], v[40:43], v[132:135], v[64:67]
    v_mfma_f32_16x16x32_bf16 v[216:219], v[44:47], v[132:135], v[216:219]
    v_mfma_f32_16x16x32_bf16 v[224:227], v[44:47], v[128:131], v[224:227]
    s_waitcnt lgkmcnt(0)
    v_mfma_f32_16x16x32_bf16 v[60:63], v[24:27], v[128:131], v[60:63]
    v_mfma_f32_16x16x32_bf16 v[68:71], v[24:27], v[132:135], v[68:71]
    v_mfma_f32_16x16x32_bf16 v[220:223], v[28:31], v[132:135], v[220:223]
    v_mfma_f32_16x16x32_bf16 v[228:231], v[28:31], v[128:131], v[228:231]
    s_nop 1
    v_fma_f32 v56, v216, s3, v56
    v_fma_f32 v57, v217, s3, v57
    v_fma_f32 v58, v218, s3, v58
    v_fma_f32 v59, v219, s3, v59
    s_nop 0
    v_fma_f32 v60, v220, s3, v60
    v_fma_f32 v61, v221, s3, v61
    v_fma_f32 v62, v222, s3, v62
    v_fma_f32 v63, v223, s3, v63
    v_fma_f32 v64, -v224, s3, v64
    v_fma_f32 v65, -v225, s3, v65
    v_fma_f32 v66, -v226, s3, v66
    v_fma_f32 v67, -v227, s3, v67
    v_fma_f32 v68, -v228, s3, v68
    v_fma_f32 v69, -v229, s3, v69
    v_fma_f32 v70, -v230, s3, v70
    v_fma_f32 v71, -v231, s3, v71
    v_cvt_pk_bf16_f32 v48, v56, v57
    v_cvt_pk_bf16_f32 v49, v58, v59
    v_cvt_pk_bf16_f32 v50, v60, v61
    v_cvt_pk_bf16_f32 v51, v62, v63
    v_cvt_pk_bf16_f32 v52, v64, v65
    v_cvt_pk_bf16_f32 v53, v66, v67
    v_cvt_pk_bf16_f32 v54, v68, v69
    v_cvt_pk_bf16_f32 v55, v70, v71
    v_mfma_f32_16x16x32_bf16 v[56:59], v[48:51], v[72:75], 0
    s_nop 0
    v_mfma_f32_16x16x32_bf16 v[60:63], v[52:55], v[72:75], 0
    v_mfma_f32_16x16x32_bf16 v[56:59], v[52:55], v[76:79], v[56:59]
    v_mfma_f32_16x16x32_bf16 v[60:63], v[48:51], v[80:83], v[60:63]
    v_mfma_f32_16x16x32_bf16 v[64:67], v[48:51], v[84:87], 0
    v_mfma_f32_16x16x32_bf16 v[68:71], v[52:55], v[84:87], 0
    v_mfma_f32_16x16x32_bf16 v[64:67], v[52:55], v[88:91], v[64:67]
    v_mfma_f32_16x16x32_bf16 v[68:71], v[48:51], v[92:95], v[68:71]
    s_nop 2
    v_cvt_pk_bf16_f32 v2, v56, v57
    v_cvt_pk_bf16_f32 v3, v58, v59
    v_cvt_pk_bf16_f32 v4, v60, v61
    v_cvt_pk_bf16_f32 v5, v62, v63
    ds_write_b128 v13, v[2:5] offset:0
    ds_read_b128 v[48:51], v23 offset:0
    v_cvt_pk_bf16_f32 v6, v64, v65
    v_cvt_pk_bf16_f32 v7, v66, v67
    v_cvt_pk_bf16_f32 v8, v68, v69
    v_cvt_pk_bf16_f32 v9, v70, v71
    ds_write_b128 v13, v[6:9] offset:1024
    ds_read_b128 v[52:55], v23 offset:1024
    s_waitcnt lgkmcnt(2)
    buffer_store_dwordx4 v[48:51], v12, s[44:47], s64 offen offset:0 sc1
    s_waitcnt lgkmcnt(0)
    buffer_store_dwordx4 v[52:55], v12, s[44:47], s64 offen offset:1024 sc1
    s_cmp_eq_u32 s71, 0
    s_cbranch_scc1 L_pf_48
    buffer_load_dword v21, v20, s[20:23], s18 offen
    s_add_u32 s18, s18, s19
    s_sub_u32 s71, s71, 1
L_pf_48:
    ds_read_b128 v[24:27], v10 offset:20480
    ds_read_b128 v[28:31], v10 offset:30720
    ds_read_b128 v[32:35], v10 offset:25600
    ds_read_b128 v[36:39], v10 offset:35840
    ds_read_b128 v[40:43], v11 offset:21504
    ds_read_b128 v[44:47], v11 offset:31744
    s_waitcnt lgkmcnt(4)
    v_mfma_f32_16x16x32_bf16 v[56:59], v[24:27], v[136:139], 0
    v_mfma_f32_16x16x32_bf16 v[64:67], v[24:27], v[140:143], 0
    v_mfma_f32_16x16x32_bf16 v[216:219], v[28:31], v[140:143], 0
    v_mfma_f32_16x16x32_bf16 v[224:227], v[28:31], v[136:139], 0
    ds_read_b128 v[24:27], v11 offset:26624
    ds_read_b128 v[28:31], v11 offset:36864
    s_waitcnt lgkmcnt(4)
    v_mfma_f32_16x16x32_bf16 v[60:63], v[32:35], v[136:139], 0
    v_mfma_f32_16x16x32_bf16 v[68:71], v[32:35], v[140:143], 0
    v_mfma_f32_16x16x32_bf16 v[220:223], v[36:39], v[140:143], 0
    v_mfma_f32_16x16x32_bf16 v[228:231], v[36:39], v[136:139], 0
    ds_read_b128 v[32:35], v10 offset:22528
    ds_read_b128 v[36:39], v10 offset:32768
    s_waitcnt lgkmcnt(4)
    v_mfma_f32_16x16x32_bf16 v[56:59], v[40:43], v[144:147], v[56:59]
    v_mfma_f32_16x16x32_bf16 v[64:67], v[40:43], v[148:151], v[64:67]
    v_mfma_f32_16x16x32_bf16 v[216:219], v[44:47], v[148:151], v[216:219]
    v_mfma_f32_16x16x32_bf16 v[224:227], v[44:47], v[144:147], v[224:227]
    ds_read_b128 v[40:43], v10 offset:27648
    ds_read_b128 v[44:47], v10 offset:37888
    s_waitcnt lgkmcnt(4)
    v_mfma_f32_16x16x32_bf16 v[60:63], v[24:27], v[144:147], v[60:63]
    v_mfma_f32_16x16x32_bf16 v[68:71], v[24:27], v[148:151], v[68:71]
    v_mfma_f32_16x16x32_bf16 v[220:223], v[28:31], v[148:151], v[220:223]
    v_mfma_f32_16x16x32_bf16 v[228:231], v[28:31], v[144:147], v[228:231]
    ds_read_b128 v[24:27], v11 offset:23552
    ds_read_b128 v[28:31], v11 offset:33792
    s_waitcnt lgkmcnt(4)
    v_mfma_f32_16x16x32_bf16 v[56:59], v[32:35], v[152:155], v[56:59]
    v_mfma_f32_16x16x32_bf16 v[64:67], v[32:35], v[156:159], v[64:67]
    v_mfma_f32_16x16x32_bf16 v[216:219], v[36:39], v[156:159], v[216:219]
    v_mfma_f32_16x16x32_bf16 v[224:227], v[36:39], v[152:155], v[224:227]
    ds_read_b128 v[32:35], v11 offset:28672
    ds_read_b128 v[36:39], v11 offset:38912
    s_waitcnt lgkmcnt(4)
    v_mfma_f32_16x16x32_bf16 v[60:63], v[40:43], v[152:155], v[60:63]
    v_mfma_f32_16x16x32_bf16 v[68:71], v[40:43], v[156:159], v[68:71]
    v_mfma_f32_16x16x32_bf16 v[220:223], v[44:47], v[156:159], v[220:223]
    v_mfma_f32_16x16x32_bf16 v[228:231], v[44:47], v[152:155], v[228:231]
    ds_read_b128 v[40:43], v10 offset:24576
    ds_read_b128 v[44:47], v10 offset:34816
    s_waitcnt lgkmcnt(4)
    v_mfma_f32_16x16x32_bf16 v[56:59], v[24:27], v[160:163], v[56:59]
    v_mfma_f32_16x16x32_bf16 v[64:67], v[24:27], v[164:167], v[64:67]
    v_mfma_f32_16x16x32_bf16 v[216:219], v[28:31], v[164:167], v[216:219]
    v_mfma_f32_16x16x32_bf16 v[224:227], v[28:31], v[160:163], v[224:227]
    ds_read_b128 v[24:27], v10 offset:29696
    ds_read_b128 v[28:31], v10 offset:39936
    s_waitcnt lgkmcnt(4)
    v_mfma_f32_16x16x32_bf16 v[60:63], v[32:35], v[160:163], v[60:63]
    v_mfma_f32_16x16x32_bf16 v[68:71], v[32:35], v[164:167], v[68:71]
    v_mfma_f32_16x16x32_bf16 v[220:223], v[36:39], v[164:167], v[220:223]
    v_mfma_f32_16x16x32_bf16 v[228:231], v[36:39], v[160:163], v[228:231]
    s_waitcnt lgkmcnt(2)
    v_mfma_f32_16x16x32_bf16 v[56:59], v[40:43], v[168:171], v[56:59]
    v_mfma_f32_16x16x32_bf16 v[64:67], v[40:43], v[172:175], v[64:67]
    v_mfma_f32_16x16x32_bf16 v[216:219], v[44:47], v[172:175], v[216:219]
    v_mfma_f32_16x16x32_bf16 v[224:227], v[44:47], v[168:171], v[224:227]
    s_waitcnt lgkmcnt(0)
    v_mfma_f32_16x16x32_bf16 v[60:63], v[24:27], v[168:171], v[60:63]
    v_mfma_f32_16x16x32_bf16 v[68:71], v[24:27], v[172:175], v[68:71]
    v_mfma_f32_16x16x32_bf16 v[220:223], v[28:31], v[172:175], v[220:223]
    v_mfma_f32_16x16x32_bf16 v[228:231], v[28:31], v[168:171], v[228:231]
    s_nop 1
    v_fma_f32 v56, v216, s3, v56
    v_fma_f32 v57, v217, s3, v57
    v_fma_f32 v58, v218, s3, v58
    v_fma_f32 v59, v219, s3, v59
    s_nop 0
    v_fma_f32 v60, v220, s3, v60
    v_fma_f32 v61, v221, s3, v61
    v_fma_f32 v62, v222, s3, v62
    v_fma_f32 v63, v223, s3, v63
    v_fma_f32 v64, -v224, s3, v64
    v_fma_f32 v65, -v225, s3, v65
    v_fma_f32 v66, -v226, s3, v66
    v_fma_f32 v67, -v227, s3, v67
    v_fma_f32 v68, -v228, s3, v68
    v_fma_f32 v69, -v229, s3, v69
    v_fma_f32 v70, -v230, s3, v70
    v_fma_f32 v71, -v231, s3, v71
    v_cvt_pk_bf16_f32 v48, v56, v57
    v_cvt_pk_bf16_f32 v49, v58, v59
    v_cvt_pk_bf16_f32 v50, v60, v61
    v_cvt_pk_bf16_f32 v51, v62, v63
    v_cvt_pk_bf16_f32 v52, v64, v65
    v_cvt_pk_bf16_f32 v53, v66, v67
    v_cvt_pk_bf16_f32 v54, v68, v69
    v_cvt_pk_bf16_f32 v55, v70, v71
    v_mfma_f32_16x16x32_bf16 v[56:59], v[48:51], v[72:75], 0
    s_nop 0
    v_mfma_f32_16x16x32_bf16 v[60:63], v[52:55], v[72:75], 0
    v_mfma_f32_16x16x32_bf16 v[56:59], v[52:55], v[76:79], v[56:59]
    v_mfma_f32_16x16x32_bf16 v[60:63], v[48:51], v[80:83], v[60:63]
    v_mfma_f32_16x16x32_bf16 v[64:67], v[48:51], v[84:87], 0
    v_mfma_f32_16x16x32_bf16 v[68:71], v[52:55], v[84:87], 0
    v_mfma_f32_16x16x32_bf16 v[64:67], v[52:55], v[88:91], v[64:67]
    v_mfma_f32_16x16x32_bf16 v[68:71], v[48:51], v[92:95], v[68:71]
    s_nop 2
    v_cvt_pk_bf16_f32 v2, v56, v57
    v_cvt_pk_bf16_f32 v3, v58, v59
    v_cvt_pk_bf16_f32 v4, v60, v61
    v_cvt_pk_bf16_f32 v5, v62, v63
    ds_write_b128 v13, v[2:5] offset:0
    ds_read_b128 v[48:51], v23 offset:0
    v_cvt_pk_bf16_f32 v6, v64, v65
    v_cvt_pk_bf16_f32 v7, v66, v67
    v_cvt_pk_bf16_f32 v8, v68, v69
    v_cvt_pk_bf16_f32 v9, v70, v71
    ds_write_b128 v13, v[6:9] offset:1024
    ds_read_b128 v[52:55], v23 offset:1024
    s_waitcnt lgkmcnt(2)
    buffer_store_dwordx4 v[48:51], v12, s[44:47], s65 offen offset:0 sc1
    s_waitcnt lgkmcnt(0)
    buffer_store_dwordx4 v[52:55], v12, s[44:47], s65 offen offset:1024 sc1
    s_cmp_le_u32 s68, 2
    s_cbranch_scc1 L_B_done
    ds_read_b128 v[24:27], v10 offset:20480
    ds_read_b128 v[28:31], v10 offset:30720
    ds_read_b128 v[32:35], v10 offset:25600
    ds_read_b128 v[36:39], v10 offset:35840
    ds_read_b128 v[40:43], v11 offset:21504
    ds_read_b128 v[44:47], v11 offset:31744
    s_waitcnt lgkmcnt(4)
    v_mfma_f32_16x16x32_bf16 v[56:59], v[24:27], v[176:179], 0
    v_mfma_f32_16x16x32_bf16 v[64:67], v[24:27], v[180:183], 0
    v_mfma_f32_16x16x32_bf16 v[216:219], v[28:31], v[180:183], 0
    v_mfma_f32_16x16x32_bf16 v[224:227], v[28:31], v[176:179], 0
    ds_read_b128 v[24:27], v11 offset:26624
    ds_read_b128 v[28:31], v11 offset:36864
    s_waitcnt lgkmcnt(4)
    v_mfma_f32_16x16x32_bf16 v[60:63], v[32:35], v[176:179], 0
    v_mfma_f32_16x16x32_bf16 v[68:71], v[32:35], v[180:183], 0
    v_mfma_f32_16x16x32_bf16 v[220:223], v[36:39], v[180:183], 0
    v_mfma_f32_16x16x32_bf16 v[228:231], v[36:39], v[176:179], 0
    ds_read_b128 v[32:35], v10 offset:22528
    ds_read_b128 v[36:39], v10 offset:32768
    s_waitcnt lgkmcnt(4)
    v_mfma_f32_16x16x32_bf16 v[56:59], v[40:43], v[184:187], v[56:59]
    v_mfma_f32_16x16x32_bf16 v[64:67], v[40:43], v[188:191], v[64:67]
    v_mfma_f32_16x16x32_bf16 v[216:219], v[44:47], v[188:191], v[216:219]
    v_mfma_f32_16x16x32_bf16 v[224:227], v[44:47], v[184:187], v[224:227]
    ds_read_b128 v[40:43], v10 offset:27648
    ds_read_b128 v[44:47], v10 offset:37888
    s_waitcnt lgkmcnt(4)
    v_mfma_f32_16x16x32_bf16 v[60:63], v[24:27], v[184:187], v[60:63]
    v_mfma_f32_16x16x32_bf16 v[68:71], v[24:27], v[188:191], v[68:71]
    v_mfma_f32_16x16x32_bf16 v[220:223], v[28:31], v[188:191], v[220:223]
    v_mfma_f32_16x16x32_bf16 v[228:231], v[28:31], v[184:187], v[228:231]
    ds_read_b128 v[24:27], v11 offset:23552
    ds_read_b128 v[28:31], v11 offset:33792
    s_waitcnt lgkmcnt(4)
    v_mfma_f32_16x16x32_bf16 v[56:59], v[32:35], v[192:195], v[56:59]
    v_mfma_f32_16x16x32_bf16 v[64:67], v[32:35], v[196:199], v[64:67]
    v_mfma_f32_16x16x32_bf16 v[216:219], v[36:39], v[196:199], v[216:219]
    v_mfma_f32_16x16x32_bf16 v[224:227], v[36:39], v[192:195], v[224:227]
    ds_read_b128 v[32:35], v11 offset:28672
    ds_read_b128 v[36:39], v11 offset:38912
    s_waitcnt lgkmcnt(4)
    v_mfma_f32_16x16x32_bf16 v[60:63], v[40:43], v[192:195], v[60:63]
    v_mfma_f32_16x16x32_bf16 v[68:71], v[40:43], v[196:199], v[68:71]
    v_mfma_f32_16x16x32_bf16 v[220:223], v[44:47], v[196:199], v[220:223]
    v_mfma_f32_16x16x32_bf16 v[228:231], v[44:47], v[192:195], v[228:231]
    ds_read_b128 v[40:43], v10 offset:24576
    ds_read_b128 v[44:47], v10 offset:34816
    s_waitcnt lgkmcnt(4)
    v_mfma_f32_16x16x32_bf16 v[56:59], v[24:27], v[200:203], v[56:59]
    v_mfma_f32_16x16x32_bf16 v[64:67], v[24:27], v[204:207], v[64:67]
    v_mfma_f32_16x16x32_bf16 v[216:219], v[28:31], v[204:207], v[216:219]
    v_mfma_f32_16x16x32_bf16 v[224:227], v[28:31], v[200:203], v[224:227]
    ds_read_b128 v[24:27], v10 offset:29696
    ds_read_b128 v[28:31], v10 offset:39936
    s_waitcnt lgkmcnt(4)
    v_mfma_f32_16x16x32_bf16 v[60:63], v[32:35], v[200:203], v[60:63]
    v_mfma_f32_16x16x32_bf16 v[68:71], v[32:35], v[204:207], v[68:71]
    v_mfma_f32_16x16x32_bf16 v[220:223], v[36:39], v[204:207], v[220:223]
    v_mfma_f32_16x16x32_bf16 v[228:231], v[36:39], v[200:203], v[228:231]
    s_waitcnt lgkmcnt(2)
    v_mfma_f32_16x16x32_bf16 v[56:59], v[40:43], v[208:211], v[56:59]
    v_mfma_f32_16x16x32_bf16 v[64:67], v[40:43], v[212:215], v[64:67]
    v_mfma_f32_16x16x32_bf16 v[216:219], v[44:47], v[212:215], v[216:219]
    v_mfma_f32_16x16x32_bf16 v[224:227], v[44:47], v[208:211], v[224:227]
    s_waitcnt lgkmcnt(0)
    v_mfma_f32_16x16x32_bf16 v[60:63], v[24:27], v[208:211], v[60:63]
    v_mfma_f32_16x16x32_bf16 v[68:71], v[24:27], v[212:215], v[68:71]
    v_mfma_f32_16x16x32_bf16 v[220:223], v[28:31], v[212:215], v[220:223]
    v_mfma_f32_16x16x32_bf16 v[228:231], v[28:31], v[208:211], v[228:231]
    s_nop 1
    v_fma_f32 v56, v216, s3, v56
    v_fma_f32 v57, v217, s3, v57
    v_fma_f32 v58, v218, s3, v58
    v_fma_f32 v59, v219, s3, v59
    s_nop 0
    v_fma_f32 v60, v220, s3, v60
    v_fma_f32 v61, v221, s3, v61
    v_fma_f32 v62, v222, s3, v62
    v_fma_f32 v63, v223, s3, v63
    v_fma_f32 v64, -v224, s3, v64
    v_fma_f32 v65, -v225, s3, v65
    v_fma_f32 v66, -v226, s3, v66
    v_fma_f32 v67, -v227, s3, v67
    v_fma_f32 v68, -v228, s3, v68
    v_fma_f32 v69, -v229, s3, v69
    v_fma_f32 v70, -v230, s3, v70
    v_fma_f32 v71, -v231, s3, v71
    v_cvt_pk_bf16_f32 v48, v56, v57
    v_cvt_pk_bf16_f32 v49, v58, v59
    v_cvt_pk_bf16_f32 v50, v60, v61
    v_cvt_pk_bf16_f32 v51, v62, v63
    v_cvt_pk_bf16_f32 v52, v64, v65
    v_cvt_pk_bf16_f32 v53, v66, v67
    v_cvt_pk_bf16_f32 v54, v68, v69
    v_cvt_pk_bf16_f32 v55, v70, v71
    v_mfma_f32_16x16x32_bf16 v[56:59], v[48:51], v[72:75], 0
    s_nop 0
    v_mfma_f32_16x16x32_bf16 v[60:63], v[52:55], v[72:75], 0
    v_mfma_f32_16x16x32_bf16 v[56:59], v[52:55], v[76:79], v[56:59]
    v_mfma_f32_16x16x32_bf16 v[60:63], v[48:51], v[80:83], v[60:63]
    v_mfma_f32_16x16x32_bf16 v[64:67], v[48:51], v[84:87], 0
    v_mfma_f32_16x16x32_bf16 v[68:71], v[52:55], v[84:87], 0
    v_mfma_f32_16x16x32_bf16 v[64:67], v[52:55], v[88:91], v[64:67]
    v_mfma_f32_16x16x32_bf16 v[68:71], v[48:51], v[92:95], v[68:71]
    s_nop 2
    v_cvt_pk_bf16_f32 v2, v56, v57
    v_cvt_pk_bf16_f32 v3, v58, v59
    v_cvt_pk_bf16_f32 v4, v60, v61
    v_cvt_pk_bf16_f32 v5, v62, v63
    ds_write_b128 v13, v[2:5] offset:0
    ds_read_b128 v[48:51], v23 offset:0
    v_cvt_pk_bf16_f32 v6, v64, v65
    v_cvt_pk_bf16_f32 v7, v66, v67
    v_cvt_pk_bf16_f32 v8, v68, v69
    v_cvt_pk_bf16_f32 v9, v70, v71
    ds_write_b128 v13, v[6:9] offset:1024
    ds_read_b128 v[52:55], v23 offset:1024
    s_waitcnt lgkmcnt(2)
    buffer_store_dwordx4 v[48:51], v12, s[44:47], s66 offen offset:0 sc1
    s_waitcnt lgkmcnt(0)
    buffer_store_dwordx4 v[52:55], v12, s[44:47], s66 offen offset:1024 sc1
    s_branch L_B_done
L_B_lu:
    s_cmp_ge_u32 s64, 30720
    s_cselect_b32 s58, 0, 10240
    s_cmp_lt_u32 s64, 20480
    s_cselect_b32 s58, 0, s58
    v_add_u32 v44, s58, v10
    v_add_u32 v45, s58, v11
    ds_read_b128 v[24:27], v44 offset:0
    ds_read_b128 v[28:31], v44 offset:5120
    ds_read_b128 v[32:35], v45 offset:1024
    ds_read_b128 v[36:39], v45 offset:6144
    ds_read_b128 v[40:43], v44 offset:2048
    s_waitcnt lgkmcnt(4)
    v_mfma_f32_16x16x32_bf16 v[56:59], v[24:27], v[96:99], 0
    v_mfma_f32_16x16x32_bf16 v[64:67], v[24:27], v[100:103], 0
    ds_read_b128 v[24:27], v44 offset:7168
    s_waitcnt lgkmcnt(4)
    v_mfma_f32_16x16x32_bf16 v[60:63], v[28:31], v[96:99], 0
    v_mfma_f32_16x16x32_bf16 v[68:71], v[28:31], v[100:103], 0
    ds_read_b128 v[28:31], v45 offset:3072
    s_waitcnt lgkmcnt(4)
    v_mfma_f32_16x16x32_bf16 v[56:59], v[32:35], v[104:107], v[56:59]
    v_mfma_f32_16x16x32_bf16 v[64:67], v[32:35], v[108:111], v[64:67]
    ds_read_b128 v[32:35], v45 offset:8192
    s_waitcnt lgkmcnt(4)
    v_mfma_f32_16x16x32_bf16 v[60:63], v[36:39], v[104:107], v[60:63]
    v_mfma_f32_16x16x32_bf16 v[68:71], v[36:39], v[108:111], v[68:71]
    ds_read_b128 v[36:39], v44 offset:4096
    s_waitcnt lgkmcnt(4)
    v_mfma_f32_16x16x32_bf16 v[56:59], v[40:43], v[112:115], v[56:59]
    v_mfma_f32_16x16x32_bf16 v[64:67], v[40:43], v[116:119], v[64:67]
    ds_read_b128 v[40:43], v44 offset:9216
    s_waitcnt lgkmcnt(4)
    v_mfma_f32_16x16x32_bf16 v[60:63], v[24:27], v[112:115], v[60:63]
    v_mfma_f32_16x16x32_bf16 v[68:71], v[24:27], v[116:119], v[68:71]
    s_waitcnt lgkmcnt(3)
    v_mfma_f32_16x16x32_bf16 v[56:59], v[28:31], v[120:123], v[56:59]
    v_mfma_f32_16x16x32_bf16 v[64:67], v[28:31], v[124:127], v[64:67]
    s_waitcnt lgkmcnt(2)
    v_mfma_f32_16x16x32_bf16 v[60:63], v[32:35], v[120:123], v[60:63]
    v_mfma_f32_16x16x32_bf16 v[68:71], v[32:35], v[124:127], v[68:71]
    s_waitcnt lgkmcnt(1)
    v_mfma_f32_16x16x32_bf16 v[56:59], v[36:39], v[128:131], v[56:59]
    v_mfma_f32_16x16x32_bf16 v[64:67], v[36:39], v[132:135], v[64:67]
    s_waitcnt lgkmcnt(0)
    v_mfma_f32_16x16x32_bf16 v[60:63], v[40:43], v[128:131], v[60:63]
    v_mfma_f32_16x16x32_bf16 v[68:71], v[40:43], v[132:135], v[68:71]
    s_nop 3
    v_cvt_pk_bf16_f32 v48, v56, v57
    v_cvt_pk_bf16_f32 v49, v58, v59
    s_nop 0
    v_cvt_pk_bf16_f32 v50, v60, v61
    v_cvt_pk_bf16_f32 v51, v62, v63
    v_cvt_pk_bf16_f32 v52, v64, v65
    v_cvt_pk_bf16_f32 v53, v66, v67
    v_cvt_pk_bf16_f32 v54, v68, v69
    v_cvt_pk_bf16_f32 v55, v70, v71
    v_mfma_f32_16x16x32_bf16 v[56:59], v[48:51], v[72:75], 0
    s_nop 0
    v_mfma_f32_16x16x32_bf16 v[60:63], v[52:55], v[72:75], 0
    v_mfma_f32_16x16x32_bf16 v[56:59], v[52:55], v[76:79], v[56:59]
    v_mfma_f32_16x16x32_bf16 v[60:63], v[48:51], v[80:83], v[60:63]
    v_mfma_f32_16x16x32_bf16 v[64:67], v[48:51], v[84:87], 0
    v_mfma_f32_16x16x32_bf16 v[68:71], v[52:55], v[84:87], 0
    v_mfma_f32_16x16x32_bf16 v[64:67], v[52:55], v[88:91], v[64:67]
    v_mfma_f32_16x16x32_bf16 v[68:71], v[48:51], v[92:95], v[68:71]
    s_nop 2
    v_cvt_pk_bf16_f32 v2, v56, v57
    v_cvt_pk_bf16_f32 v3, v58, v59
    v_cvt_pk_bf16_f32 v4, v60, v61
    v_cvt_pk_bf16_f32 v5, v62, v63
    ds_write_b128 v13, v[2:5] offset:0
    ds_read_b128 v[48:51], v23 offset:0
    v_cvt_pk_bf16_f32 v6, v64, v65
    v_cvt_pk_bf16_f32 v7, v66, v67
    v_cvt_pk_bf16_f32 v8, v68, v69
    v_cvt_pk_bf16_f32 v9, v70, v71
    ds_write_b128 v13, v[6:9] offset:1024
    ds_read_b128 v[52:55], v23 offset:1024
    s_waitcnt lgkmcnt(2)
    buffer_store_dwordx4 v[48:51], v12, s[44:47], s64 offen offset:0 sc1
    s_waitcnt lgkmcnt(0)
    buffer_store_dwordx4 v[52:55], v12, s[44:47], s64 offen offset:1024 sc1
    s_cmp_eq_u32 s71, 0
    s_cbranch_scc1 L_pf_49
    buffer_load_dword v21, v20, s[20:23], s18 offen
    s_add_u32 s18, s18, s19
    s_sub_u32 s71, s71, 1
L_pf_49:
    s_cmp_ge_u32 s65, 30720
    s_cselect_b32 s58, 0, 10240
    s_cmp_lt_u32 s65, 20480
    s_cselect_b32 s58, 0, s58
    v_add_u32 v44, s58, v10
    v_add_u32 v45, s58, v11
    ds_read_b128 v[24:27], v44 offset:0
    ds_read_b128 v[28:31], v44 offset:5120
    ds_read_b128 v[32:35], v45 offset:1024
    ds_read_b128 v[36:39], v45 offset:6144
    ds_read_b128 v[40:43], v44 offset:2048
    s_waitcnt lgkmcnt(4)
    v_mfma_f32_16x16x32_bf16 v[56:59], v[24:27], v[136:139], 0
    v_mfma_f32_16x16x32_bf16 v[64:67], v[24:27], v[140:143], 0
    ds_read_b128 v[24:27], v44 offset:7168
    s_waitcnt lgkmcnt(4)
    v_mfma_f32_16x16x32_bf16 v[60:63], v[28:31], v[136:139], 0
    v_mfma_f32_16x16x32_bf16 v[68:71], v[28:31], v[140:143], 0
    ds_read_b128 v[28:31], v45 offset:3072
    s_waitcnt lgkmcnt(4)
    v_mfma_f32_16x16x32_bf16 v[56:59], v[32:35], v[144:147], v[56:59]
    v_mfma_f32_16x16x32_bf16 v[64:67], v[32:35], v[148:151], v[64:67]
    ds_read_b128 v[32:35], v45 offset:8192
    s_waitcnt lgkmcnt(4)
    v_mfma_f32_16x16x32_bf16 v[60:63], v[36:39], v[144:147], v[60:63]
    v_mfma_f32_16x16x32_bf16 v[68:71], v[36:39], v[148:151], v[68:71]
    ds_read_b128 v[36:39], v44 offset:4096
    s_waitcnt lgkmcnt(4)
    v_mfma_f32_16x16x32_bf16 v[56:59], v[40:43], v[152:155], v[56:59]
    v_mfma_f32_16x16x32_bf16 v[64:67], v[40:43], v[156:159], v[64:67]
    ds_read_b128 v[40:43], v44 offset:9216
    s_waitcnt lgkmcnt(4)
    v_mfma_f32_16x16x32_bf16 v[60:63], v[24:27], v[152:155], v[60:63]
    v_mfma_f32_16x16x32_bf16 v[68:71], v[24:27], v[156:159], v[68:71]
    s_waitcnt lgkmcnt(3)
    v_mfma_f32_16x16x32_bf16 v[56:59], v[28:31], v[160:163], v[56:59]
    v_mfma_f32_16x16x32_bf16 v[64:67], v[28:31], v[164:167], v[64:67]
    s_waitcnt lgkmcnt(2)
    v_mfma_f32_16x16x32_bf16 v[60:63], v[32:35], v[160:163], v[60:63]
    v_mfma_f32_16x16x32_bf16 v[68:71], v[32:35], v[164:167], v[68:71]
    s_waitcnt lgkmcnt(1)
    v_mfma_f32_16x16x32_bf16 v[56:59], v[36:39], v[168:171], v[56:59]
    v_mfma_f32_16x16x32_bf16 v[64:67], v[36:39], v[172:175], v[64:67]
    s_waitcnt lgkmcnt(0)
    v_mfma_f32_16x16x32_bf16 v[60:63], v[40:43], v[168:171], v[60:63]
    v_mfma_f32_16x16x32_bf16 v[68:71], v[40:43], v[172:175], v[68:71]
    s_nop 3
    v_cvt_pk_bf16_f32 v48, v56, v57
    v_cvt_pk_bf16_f32 v49, v58, v59
    s_nop 0
    v_cvt_pk_bf16_f32 v50, v60, v61
    v_cvt_pk_bf16_f32 v51, v62, v63
    v_cvt_pk_bf16_f32 v52, v64, v65
    v_cvt_pk_bf16_f32 v53, v66, v67
    v_cvt_pk_bf16_f32 v54, v68, v69
    v_cvt_pk_bf16_f32 v55, v70, v71
    v_mfma_f32_16x16x32_bf16 v[56:59], v[48:51], v[72:75], 0
    s_nop 0
    v_mfma_f32_16x16x32_bf16 v[60:63], v[52:55], v[72:75], 0
    v_mfma_f32_16x16x32_bf16 v[56:59], v[52:55], v[76:79], v[56:59]
    v_mfma_f32_16x16x32_bf16 v[60:63], v[48:51], v[80:83], v[60:63]
    v_mfma_f32_16x16x32_bf16 v[64:67], v[48:51], v[84:87], 0
    v_mfma_f32_16x16x32_bf16 v[68:71], v[52:55], v[84:87], 0
    v_mfma_f32_16x16x32_bf16 v[64:67], v[52:55], v[88:91], v[64:67]
    v_mfma_f32_16x16x32_bf16 v[68:71], v[48:51], v[92:95], v[68:71]
    s_nop 2
    v_cvt_pk_bf16_f32 v2, v56, v57
    v_cvt_pk_bf16_f32 v3, v58, v59
    v_cvt_pk_bf16_f32 v4, v60, v61
    v_cvt_pk_bf16_f32 v5, v62, v63
    ds_write_b128 v13, v[2:5] offset:0
    ds_read_b128 v[48:51], v23 offset:0
    v_cvt_pk_bf16_f32 v6, v64, v65
    v_cvt_pk_bf16_f32 v7, v66, v67
    v_cvt_pk_bf16_f32 v8, v68, v69
    v_cvt_pk_bf16_f32 v9, v70, v71
    ds_write_b128 v13, v[6:9] offset:1024
    ds_read_b128 v[52:55], v23 offset:1024
    s_waitcnt lgkmcnt(2)
    buffer_store_dwordx4 v[48:51], v12, s[44:47], s65 offen offset:0 sc1
    s_waitcnt lgkmcnt(0)
    buffer_store_dwordx4 v[52:55], v12, s[44:47], s65 offen offset:1024 sc1
    s_cmp_le_u32 s68, 2
    s_cbranch_scc1 L_B_done
    s_cmp_ge_u32 s66, 30720
    s_cselect_b32 s58, 0, 10240
    s_cmp_lt_u32 s66, 20480
    s_cselect_b32 s58, 0, s58
    v_add_u32 v44, s58, v10
    v_add_u32 v45, s58, v11
    ds_read_b128 v[24:27], v44 offset:0
    ds_read_b128 v[28:31], v44 offset:5120
    ds_read_b128 v[32:35], v45 offset:1024
    ds_read_b128 v[36:39], v45 offset:6144
    ds_read_b128 v[40:43], v44 offset:2048
    s_waitcnt lgkmcnt(4)
    v_mfma_f32_16x16x32_bf16 v[56:59], v[24:27], v[176:179], 0
    v_mfma_f32_16x16x32_bf16 v[64:67], v[24:27], v[180:183], 0
    ds_read_b128 v[24:27], v44 offset:7168
    s_waitcnt lgkmcnt(4)
    v_mfma_f32_16x16x32_bf16 v[60:63], v[28:31], v[176:179], 0
    v_mfma_f32_16x16x32_bf16 v[68:71], v[28:31], v[180:183], 0
    ds_read_b128 v[28:31], v45 offset:3072
    s_waitcnt lgkmcnt(4)
    v_mfma_f32_16x16x32_bf16 v[56:59], v[32:35], v[184:187], v[56:59]
    v_mfma_f32_16x16x32_bf16 v[64:67], v[32:35], v[188:191], v[64:67]
    ds_read_b128 v[32:35], v45 offset:8192
    s_waitcnt lgkmcnt(4)
    v_mfma_f32_16x16x32_bf16 v[60:63], v[36:39], v[184:187], v[60:63]
    v_mfma_f32_16x16x32_bf16 v[68:71], v[36:39], v[188:191], v[68:71]
    ds_read_b128 v[36:39], v44 offset:4096
    s_waitcnt lgkmcnt(4)
    v_mfma_f32_16x16x32_bf16 v[56:59], v[40:43], v[192:195], v[56:59]
    v_mfma_f32_16x16x32_bf16 v[64:67], v[40:43], v[196:199], v[64:67]
    ds_read_b128 v[40:43], v44 offset:9216
    s_waitcnt lgkmcnt(4)
    v_mfma_f32_16x16x32_bf16 v[60:63], v[24:27], v[192:195], v[60:63]
    v_mfma_f32_16x16x32_bf16 v[68:71], v[24:27], v[196:199], v[68:71]
    s_waitcnt lgkmcnt(3)
    v_mfma_f32_16x16x32_bf16 v[56:59], v[28:31], v[200:203], v[56:59]
    v_mfma_f32_16x16x32_bf16 v[64:67], v[28:31], v[204:207], v[64:67]
    s_waitcnt lgkmcnt(2)
    v_mfma_f32_16x16x32_bf16 v[60:63], v[32:35], v[200:203], v[60:63]
    v_mfma_f32_16x16x32_bf16 v[68:71], v[32:35], v[204:207], v[68:71]
    s_waitcnt lgkmcnt(1)
    v_mfma_f32_16x16x32_bf16 v[56:59], v[36:39], v[208:211], v[56:59]
    v_mfma_f32_16x16x32_bf16 v[64:67], v[36:39], v[212:215], v[64:67]
    s_waitcnt lgkmcnt(0)
    v_mfma_f32_16x16x32_bf16 v[60:63], v[40:43], v[208:211], v[60:63]
    v_mfma_f32_16x16x32_bf16 v[68:71], v[40:43], v[212:215], v[68:71]
    s_nop 3
    v_cvt_pk_bf16_f32 v48, v56, v57
    v_cvt_pk_bf16_f32 v49, v58, v59
    s_nop 0
    v_cvt_pk_bf16_f32 v50, v60, v61
    v_cvt_pk_bf16_f32 v51, v62, v63
    v_cvt_pk_bf16_f32 v52, v64, v65
    v_cvt_pk_bf16_f32 v53, v66, v67
    v_cvt_pk_bf16_f32 v54, v68, v69
    v_cvt_pk_bf16_f32 v55, v70, v71
    v_mfma_f32_16x16x32_bf16 v[56:59], v[48:51], v[72:75], 0
    s_nop 0
    v_mfma_f32_16x16x32_bf16 v[60:63], v[52:55], v[72:75], 0
    v_mfma_f32_16x16x32_bf16 v[56:59], v[52:55], v[76:79], v[56:59]
    v_mfma_f32_16x16x32_bf16 v[60:63], v[48:51], v[80:83], v[60:63]
    v_mfma_f32_16x16x32_bf16 v[64:67], v[48:51], v[84:87], 0
    v_mfma_f32_16x16x32_bf16 v[68:71], v[52:55], v[84:87], 0
    v_mfma_f32_16x16x32_bf16 v[64:67], v[52:55], v[88:91], v[64:67]
    v_mfma_f32_16x16x32_bf16 v[68:71], v[48:51], v[92:95], v[68:71]
    s_nop 2
    v_cvt_pk_bf16_f32 v2, v56, v57
    v_cvt_pk_bf16_f32 v3, v58, v59
    v_cvt_pk_bf16_f32 v4, v60, v61
    v_cvt_pk_bf16_f32 v5, v62, v63
    ds_write_b128 v13, v[2:5] offset:0
    ds_read_b128 v[48:51], v23 offset:0
    v_cvt_pk_bf16_f32 v6, v64, v65
    v_cvt_pk_bf16_f32 v7, v66, v67
    v_cvt_pk_bf16_f32 v8, v68, v69
    v_cvt_pk_bf16_f32 v9, v70, v71
    ds_write_b128 v13, v[6:9] offset:1024
    ds_read_b128 v[52:55], v23 offset:1024
    s_waitcnt lgkmcnt(2)
    buffer_store_dwordx4 v[48:51], v12, s[44:47], s66 offen offset:0 sc1
    s_waitcnt lgkmcnt(0)
    buffer_store_dwordx4 v[52:55], v12, s[44:47], s66 offen offset:1024 sc1
    s_cmp_le_u32 s68, 3
    s_cbranch_scc1 L_B_done
    s_cmp_ge_u32 s67, 30720
    s_cselect_b32 s58, 0, 10240
    s_cmp_lt_u32 s67, 20480
    s_cselect_b32 s58, 0, s58
    v_add_u32 v44, s58, v10
    v_add_u32 v45, s58, v11
    v_lshl_add_u32 v1, v14, 2, s63
    v_cvt_f32_u32 v1, v1
    v_mul_f32 v1, 0x3acccccd, v1
    v_mul_f32 v2, v1, v22
    v_mul_f32 v9, 0x42000000, v1
    v_cos_f32 v8, v1
    v_cos_f32 v9, v9
    v_fmamk_f32 v3, v1, 0x0, v2
    v_fmamk_f32 v56, v1, 0x3f800000, v2
    v_cos_f32 v4, v3
    v_cos_f32 v6, v56
    v_sin_f32 v5, -v3
    v_sin_f32 v7, -v56
    v_add_f32 v8, v8, v8
    v_add_f32 v9, v9, v9
    v_cvt_pk_bf16_f32 v216, v4, v6
    v_pk_fma_f32 v[56:57], v[8:9], v[6:7], v[4:5] op_sel:[0,0,0] op_sel_hi:[0,1,1] neg_lo:[0,0,1] neg_hi:[0,0,1]
    v_cvt_pk_bf16_f32 v220, v5, v7
    v_pk_fma_f32 v[58:59], v[8:9], v[56:57], v[6:7] op_sel:[0,0,0] op_sel_hi:[0,1,1] neg_lo:[0,0,1] neg_hi:[0,0,1]
    v_pk_fma_f32 v[60:61], v[8:9], v[58:59], v[56:57] op_sel:[0,0,0] op_sel_hi:[0,1,1] neg_lo:[0,0,1] neg_hi:[0,0,1]
    v_cvt_pk_bf16_f32 v217, v56, v58
    v_pk_fma_f32 v[62:63], v[8:9], v[60:61], v[58:59] op_sel:[0,0,0] op_sel_hi:[0,1,1] neg_lo:[0,0,1] neg_hi:[0,0,1]
    v_cvt_pk_bf16_f32 v221, v57, v59
    v_pk_fma_f32 v[64:65], v[8:9], v[62:63], v[60:61] op_sel:[0,0,0] op_sel_hi:[0,1,1] neg_lo:[0,0,1] neg_hi:[0,0,1]
    v_cvt_pk_bf16_f32 v218, v60, v62
    v_pk_fma_f32 v[66:67], v[8:9], v[64:65], v[62:63] op_sel:[0,0,0] op_sel_hi:[0,1,1] neg_lo:[0,0,1] neg_hi:[0,0,1]
    v_cvt_pk_bf16_f32 v222, v61, v63
    v_cvt_pk_bf16_f32 v219, v64, v66
    v_cvt_pk_bf16_f32 v223, v65, v67
    v_fmamk_f32 v3, v1, 0x42000000, v2
    v_fmamk_f32 v56, v1, 0x42040000, v2
    v_cos_f32 v16, v3
    v_cos_f32 v18, v56
    v_sin_f32 v17, -v3
    v_sin_f32 v19, -v56
    v_cvt_pk_bf16_f32 v224, v16, v18
    v_pk_fma_f32 v[56:57], v[8:9], v[18:19], v[16:17] op_sel:[0,0,0] op_sel_hi:[0,1,1] neg_lo:[0,0,1] neg_hi:[0,0,1]
    v_cvt_pk_bf16_f32 v228, v17, v19
    v_pk_fma_f32 v[58:59], v[8:9], v[56:57], v[18:19] op_sel:[0,0,0] op_sel_hi:[0,1,1] neg_lo:[0,0,1] neg_hi:[0,0,1]
    v_pk_fma_f32 v[60:61], v[8:9], v[58:59], v[56:57] op_sel:[0,0,0] op_sel_hi:[0,1,1] neg_lo:[0,0,1] neg_hi:[0,0,1]
    v_cvt_pk_bf16_f32 v225, v56, v58
    v_pk_fma_f32 v[62:63], v[8:9], v[60:61], v[58:59] op_sel:[0,0,0] op_sel_hi:[0,1,1] neg_lo:[0,0,1] neg_hi:[0,0,1]
    v_cvt_pk_bf16_f32 v229, v57, v59
    v_pk_fma_f32 v[64:65], v[8:9], v[62:63], v[60:61] op_sel:[0,0,0] op_sel_hi:[0,1,1] neg_lo:[0,0,1] neg_hi:[0,0,1]
    v_cvt_pk_bf16_f32 v226, v60, v62
    v_pk_fma_f32 v[66:67], v[8:9], v[64:65], v[62:63] op_sel:[0,0,0] op_sel_hi:[0,1,1] neg_lo:[0,0,1] neg_hi:[0,0,1]
    v_cvt_pk_bf16_f32 v230, v61, v63
    v_cvt_pk_bf16_f32 v227, v64, v66
    v_cvt_pk_bf16_f32 v231, v65, v67
    v_pk_fma_f32 v[4:5], v[8:9], v[16:17], v[4:5] op_sel:[1,0,0] op_sel_hi:[1,1,1] neg_lo:[0,0,1] neg_hi:[0,0,1]
    v_pk_fma_f32 v[6:7], v[8:9], v[18:19], v[6:7] op_sel:[1,0,0] op_sel_hi:[1,1,1] neg_lo:[0,0,1] neg_hi:[0,0,1]
    v_cvt_pk_bf16_f32 v232, v4, v6
    v_pk_fma_f32 v[56:57], v[8:9], v[6:7], v[4:5] op_sel:[0,0,0] op_sel_hi:[0,1,1] neg_lo:[0,0,1] neg_hi:[0,0,1]
    v_cvt_pk_bf16_f32 v236, v5, v7
    v_pk_fma_f32 v[58:59], v[8:9], v[56:57], v[6:7] op_sel:[0,0,0] op_sel_hi:[0,1,1] neg_lo:[0,0,1] neg_hi:[0,0,1]
    v_pk_fma_f32 v[60:61], v[8:9], v[58:59], v[56:57] op_sel:[0,0,0] op_sel_hi:[0,1,1] neg_lo:[0,0,1] neg_hi:[0,0,1]
    v_cvt_pk_bf16_f32 v233, v56, v58
    v_pk_fma_f32 v[62:63], v[8:9], v[60:61], v[58:59] op_sel:[0,0,0] op_sel_hi:[0,1,1] neg_lo:[0,0,1] neg_hi:[0,0,1]
    v_cvt_pk_bf16_f32 v237, v57, v59
    v_pk_fma_f32 v[64:65], v[8:9], v[62:63], v[60:61] op_sel:[0,0,0] op_sel_hi:[0,1,1] neg_lo:[0,0,1] neg_hi:[0,0,1]
    v_cvt_pk_bf16_f32 v234, v60, v62
    v_pk_fma_f32 v[66:67], v[8:9], v[64:65], v[62:63] op_sel:[0,0,0] op_sel_hi:[0,1,1] neg_lo:[0,0,1] neg_hi:[0,0,1]
    v_cvt_pk_bf16_f32 v238, v61, v63
    v_cvt_pk_bf16_f32 v235, v64, v66
    v_cvt_pk_bf16_f32 v239, v65, v67
    v_pk_fma_f32 v[16:17], v[8:9], v[4:5], v[16:17] op_sel:[1,0,0] op_sel_hi:[1,1,1] neg_lo:[0,0,1] neg_hi:[0,0,1]
    v_pk_fma_f32 v[18:19], v[8:9], v[6:7], v[18:19] op_sel:[1,0,0] op_sel_hi:[1,1,1] neg_lo:[0,0,1] neg_hi:[0,0,1]
    v_cvt_pk_bf16_f32 v240, v16, v18
    v_pk_fma_f32 v[56:57], v[8:9], v[18:19], v[16:17] op_sel:[0,0,0] op_sel_hi:[0,1,1] neg_lo:[0,0,1] neg_hi:[0,0,1]
    v_cvt_pk_bf16_f32 v244, v17, v19
    v_pk_fma_f32 v[58:59], v[8:9], v[56:57], v[18:19] op_sel:[0,0,0] op_sel_hi:[0,1,1] neg_lo:[0,0,1] neg_hi:[0,0,1]
    v_pk_fma_f32 v[60:61], v[8:9], v[58:59], v[56:57] op_sel:[0,0,0] op_sel_hi:[0,1,1] neg_lo:[0,0,1] neg_hi:[0,0,1]
    v_cvt_pk_bf16_f32 v241, v56, v58
    v_pk_fma_f32 v[62:63], v[8:9], v[60:61], v[58:59] op_sel:[0,0,0] op_sel_hi:[0,1,1] neg_lo:[0,0,1] neg_hi:[0,0,1]
    v_cvt_pk_bf16_f32 v245, v57, v59
    v_pk_fma_f32 v[64:65], v[8:9], v[62:63], v[60:61] op_sel:[0,0,0] op_sel_hi:[0,1,1] neg_lo:[0,0,1] neg_hi:[0,0,1]
    v_cvt_pk_bf16_f32 v242, v60, v62
    v_pk_fma_f32 v[66:67], v[8:9], v[64:65], v[62:63] op_sel:[0,0,0] op_sel_hi:[0,1,1] neg_lo:[0,0,1] neg_hi:[0,0,1]
    v_cvt_pk_bf16_f32 v246, v61, v63
    v_cvt_pk_bf16_f32 v243, v64, v66
    v_cvt_pk_bf16_f32 v247, v65, v67
    v_pk_fma_f32 v[4:5], v[8:9], v[16:17], v[4:5] op_sel:[1,0,0] op_sel_hi:[1,1,1] neg_lo:[0,0,1] neg_hi:[0,0,1]
    v_pk_fma_f32 v[6:7], v[8:9], v[18:19], v[6:7] op_sel:[1,0,0] op_sel_hi:[1,1,1] neg_lo:[0,0,1] neg_hi:[0,0,1]
    v_cvt_pk_bf16_f32 v248, v4, v6
    v_pk_fma_f32 v[56:57], v[8:9], v[6:7], v[4:5] op_sel:[0,0,0] op_sel_hi:[0,1,1] neg_lo:[0,0,1] neg_hi:[0,0,1]
    v_cvt_pk_bf16_f32 v252, v5, v7
    v_pk_fma_f32 v[58:59], v[8:9], v[56:57], v[6:7] op_sel:[0,0,0] op_sel_hi:[0,1,1] neg_lo:[0,0,1] neg_hi:[0,0,1]
    v_pk_fma_f32 v[60:61], v[8:9], v[58:59], v[56:57] op_sel:[0,0,0] op_sel_hi:[0,1,1] neg_lo:[0,0,1] neg_hi:[0,0,1]
    v_cvt_pk_bf16_f32 v249, v56, v58
    v_pk_fma_f32 v[62:63], v[8:9], v[60:61], v[58:59] op_sel:[0,0,0] op_sel_hi:[0,1,1] neg_lo:[0,0,1] neg_hi:[0,0,1]
    v_cvt_pk_bf16_f32 v253, v57, v59
    v_pk_fma_f32 v[64:65], v[8:9], v[62:63], v[60:61] op_sel:[0,0,0] op_sel_hi:[0,1,1] neg_lo:[0,0,1] neg_hi:[0,0,1]
    v_cvt_pk_bf16_f32 v250, v60, v62
    v_pk_fma_f32 v[66:67], v[8:9], v[64:65], v[62:63] op_sel:[0,0,0] op_sel_hi:[0,1,1] neg_lo:[0,0,1] neg_hi:[0,0,1]
    v_cvt_pk_bf16_f32 v254, v61, v63
    v_cvt_pk_bf16_f32 v251, v64, v66
    v_cvt_pk_bf16_f32 v255, v65, v67
    ds_read_b128 v[24:27], v44 offset:0
    ds_read_b128 v[28:31], v44 offset:5120
    ds_read_b128 v[32:35], v45 offset:1024
    ds_read_b128 v[36:39], v45 offset:6144
    ds_read_b128 v[40:43], v44 offset:2048
    s_waitcnt lgkmcnt(4)
    v_mfma_f32_16x16x32_bf16 v[56:59], v[24:27], v[216:219], 0
    v_mfma_f32_16x16x32_bf16 v[64:67], v[24:27], v[220:223], 0
    ds_read_b128 v[24:27], v44 offset:7168
    s_waitcnt lgkmcnt(4)
    v_mfma_f32_16x16x32_bf16 v[60:63], v[28:31], v[216:219], 0
    v_mfma_f32_16x16x32_bf16 v[68:71], v[28:31], v[220:223], 0
    ds_read_b128 v[28:31], v45 offset:3072
    s_waitcnt lgkmcnt(4)
    v_mfma_f32_16x16x32_bf16 v[56:59], v[32:35], v[224:227], v[56:59]
    v_mfma_f32_16x16x32_bf16 v[64:67], v[32:35], v[228:231], v[64:67]
    ds_read_b128 v[32:35], v45 offset:8192
    s_waitcnt lgkmcnt(4)
    v_mfma_f32_16x16x32_bf16 v[60:63], v[36:39], v[224:227], v[60:63]
    v_mfma_f32_16x16x32_bf16 v[68:71], v[36:39], v[228:231], v[68:71]
    ds_read_b128 v[36:39], v44 offset:4096
    s_waitcnt lgkmcnt(4)
    v_mfma_f32_16x16x32_bf16 v[56:59], v[40:43], v[232:235], v[56:59]
    v_mfma_f32_16x16x32_bf16 v[64:67], v[40:43], v[236:239], v[64:67]
    ds_read_b128 v[40:43], v44 offset:9216
    s_waitcnt lgkmcnt(4)
    v_mfma_f32_16x16x32_bf16 v[60:63], v[24:27], v[232:235], v[60:63]
    v_mfma_f32_16x16x32_bf16 v[68:71], v[24:27], v[236:239], v[68:71]
    s_waitcnt lgkmcnt(3)
    v_mfma_f32_16x16x32_bf16 v[56:59], v[28:31], v[240:243], v[56:59]
    v_mfma_f32_16x16x32_bf16 v[64:67], v[28:31], v[244:247], v[64:67]
    s_waitcnt lgkmcnt(2)
    v_mfma_f32_16x16x32_bf16 v[60:63], v[32:35], v[240:243], v[60:63]
    v_mfma_f32_16x16x32_bf16 v[68:71], v[32:35], v[244:247], v[68:71]
    s_waitcnt lgkmcnt(1)
    v_mfma_f32_16x16x32_bf16 v[56:59], v[36:39], v[248:251], v[56:59]
    v_mfma_f32_16x16x32_bf16 v[64:67], v[36:39], v[252:255], v[64:67]
    s_waitcnt lgkmcnt(0)
    v_mfma_f32_16x16x32_bf16 v[60:63], v[40:43], v[248:251], v[60:63]
    v_mfma_f32_16x16x32_bf16 v[68:71], v[40:43], v[252:255], v[68:71]
    s_nop 3
    v_cvt_pk_bf16_f32 v48, v56, v57
    v_cvt_pk_bf16_f32 v49, v58, v59
    s_nop 0
    v_cvt_pk_bf16_f32 v50, v60, v61
    v_cvt_pk_bf16_f32 v51, v62, v63
    v_cvt_pk_bf16_f32 v52, v64, v65
    v_cvt_pk_bf16_f32 v53, v66, v67
    v_cvt_pk_bf16_f32 v54, v68, v69
    v_cvt_pk_bf16_f32 v55, v70, v71
    v_mfma_f32_16x16x32_bf16 v[56:59], v[48:51], v[72:75], 0
    s_nop 0
    v_mfma_f32_16x16x32_bf16 v[60:63], v[52:55], v[72:75], 0
    v_mfma_f32_16x16x32_bf16 v[56:59], v[52:55], v[76:79], v[56:59]
    v_mfma_f32_16x16x32_bf16 v[60:63], v[48:51], v[80:83], v[60:63]
    v_mfma_f32_16x16x32_bf16 v[64:67], v[48:51], v[84:87], 0
    v_mfma_f32_16x16x32_bf16 v[68:71], v[52:55], v[84:87], 0
    v_mfma_f32_16x16x32_bf16 v[64:67], v[52:55], v[88:91], v[64:67]
    v_mfma_f32_16x16x32_bf16 v[68:71], v[48:51], v[92:95], v[68:71]
    s_nop 2
    v_cvt_pk_bf16_f32 v2, v56, v57
    v_cvt_pk_bf16_f32 v3, v58, v59
    v_cvt_pk_bf16_f32 v4, v60, v61
    v_cvt_pk_bf16_f32 v5, v62, v63
    ds_write_b128 v13, v[2:5] offset:0
    ds_read_b128 v[48:51], v23 offset:0
    v_cvt_pk_bf16_f32 v6, v64, v65
    v_cvt_pk_bf16_f32 v7, v66, v67
    v_cvt_pk_bf16_f32 v8, v68, v69
    v_cvt_pk_bf16_f32 v9, v70, v71
    ds_write_b128 v13, v[6:9] offset:1024
    ds_read_b128 v[52:55], v23 offset:1024
    s_waitcnt lgkmcnt(2)
    buffer_store_dwordx4 v[48:51], v12, s[44:47], s67 offen offset:0 sc1
    s_waitcnt lgkmcnt(0)
    buffer_store_dwordx4 v[52:55], v12, s[44:47], s67 offen offset:1024 sc1
L_B_done:
    v_mov_b32 v1, 0
    buffer_load_dword v10, v1, s[40:43], 0 offen sc1
    s_mul_i32 s60, s51, 52
    s_lshr_b32 s60, s60, 8
    s_mul_i32 s61, s60, 5
    s_sub_u32 s59, s51, s61
    s_mov_b32 s61, s59
    s_and_b32 s63, s50, 4
    s_add_u32 s60, s60, s63
    s_lshl_b32 s60, s60, 2
    s_add_u32 s60, s60, s49
    s_lshl_b32 s18, s60, 1
    s_bfe_u32 s19, s2, 0x10001
    s_and_b32 s60, s50, 1
    s_mul_i32 s60, s60, 5
    s_add_u32 s60, s60, s61
    s_lshl_b32 s58, s60, 7
    s_mov_b32 s59, 0
    s_add_u32 s60, s18, 0
    s_mul_i32 s63, s60, 373
    s_lshr_b32 s63, s63, 12
    s_mul_i32 s61, s63, 11
    s_sub_u32 s61, s60, s61
    s_add_u32 s61, s61, 1
    s_mul_i32 s61, s61, 86
    s_lshr_b32 s61, s61, 8
    s_lshl_b32 s63, s63, 1
    s_add_u32 s63, s63, s19
    s_lshl_b32 s63, s63, 2
    s_add_u32 s63, s63, s61
    s_lshl_b32 s63, s63, 8
    s_add_u32 s63, s63, 5898240
    v_mov_b32 v2, s63
    s_add_u32 s60, s18, 1
    s_mul_i32 s63, s60, 373
    s_lshr_b32 s63, s63, 12
    s_mul_i32 s61, s63, 11
    s_sub_u32 s61, s60, s61
    s_add_u32 s61, s61, 1
    s_mul_i32 s61, s61, 86
    s_lshr_b32 s61, s61, 8
    s_lshl_b32 s63, s63, 1
    s_add_u32 s63, s63, s19
    s_lshl_b32 s63, s63, 2
    s_add_u32 s63, s63, s61
    s_lshl_b32 s63, s63, 8
    s_add_u32 s63, s63, 5898240
    v_mov_b32 v3, s63
    v_cmp_gt_u32 vcc, 32, v0
    s_nop 1
    v_cndmask_b32 v9, v3, v2, vcc
    v_and_b32 v2, 1, v0
    v_bfe_u32 v2, v0, 4, 1
    s_and_b32 s60, s49, 1
    v_lshl_or_b32 v2, s60, 1, v2
    v_lshlrev_b32 v2, 1, v2
    v_and_b32 v3, 7, v0
    v_xor_b32 v2, v2, v3
    v_lshl_add_u32 v2, v2, 4, s58
    v_lshrrev_b32 v3, 5, v0
    v_bfe_u32 v4, v0, 3, 2
    v_mad_u32_u24 v40, v3, 20, v4
    s_lshl_b32 s61, s49, 2
    v_add_u32 v40, s61, v40
    v_mul_u32_u24 v40, 1280, v40
    v_add_u32 v40, v40, v2
    v_xor_b32 v3, s60, v3
    v_mad_u32_u24 v41, v3, 20, v4
    s_mul_i32 s61, s49, 40
    s_add_u32 s61, s61, 16
    v_add_u32 v41, s61, v41
    v_mul_u32_u24 v41, 1280, v41
    v_add_u32 v41, v41, v2
    s_lshl_b32 s66, s49, 10
    s_waitcnt vmcnt(0)
    s_mov_b32 s69, 0
L_dbg_50:
    v_cmp_ne_u32 vcc, 1, v10
    s_cbranch_vccz L_dbgok_51
    s_add_u32 s69, s69, 1
    s_cmp_gt_u32 s69, 1048576
    s_cbranch_scc1 L_dbgok_51
    buffer_load_dword v10, v1, s[40:43], 0 offen sc1
    s_waitcnt vmcnt(0)
    s_branch L_dbg_50
L_dbgok_51:
    s_barrier
    s_cmp_ge_u32 s48, 4
    s_cbranch_scc1 L_B_wo
    s_cmp_lg_u32 s48, 0
    s_cbranch_scc1 L_fin
    s_lshr_b32 s60, s57, 4
    s_lshl_b32 s60, s60, 8
    s_add_u32 s60, s60, 5910528
    v_mov_b32 v1, 0
    v_mov_b32 v4, 1
    v_mov_b32 v5, 1
    s_mov_b64 exec, 1
    buffer_atomic_add v4, v1, s[44:47], s60 offen sc0 sc1
    s_waitcnt vmcnt(0)
    v_cmp_eq_u32 vcc, 15, v4
    s_cbranch_vccz L_notlast_52
    buffer_store_dword v5, v1, s[44:47], s60 offen offset:128 sc1
L_notlast_52:
    s_mov_b64 exec, -1
    s_branch L_fin
L_B_wo:
    s_add_u32 m0, s66, 0
    s_mov_b32 s63, 0
    buffer_load_dwordx4 v40, s[28:31], s63 offen lds
    s_add_u32 m0, s66, 4096
    s_mov_b32 s63, 51200
    buffer_load_dwordx4 v40, s[28:31], s63 offen lds
    s_add_u32 m0, s66, 8192
    s_mov_b32 s63, 102400
    buffer_load_dwordx4 v40, s[28:31], s63 offen lds
    s_add_u32 m0, s66, 12288
    s_mov_b32 s63, 153600
    buffer_load_dwordx4 v40, s[28:31], s63 offen lds
    s_add_u32 m0, s66, 16384
    s_mov_b32 s63, 204800
    buffer_load_dwordx4 v40, s[28:31], s63 offen lds
    s_add_u32 m0, s66, 20480
    s_mov_b32 s63, 256000
    buffer_load_dwordx4 v40, s[28:31], s63 offen lds
    s_add_u32 m0, s66, 24576
    s_mov_b32 s63, 307200
    buffer_load_dwordx4 v40, s[28:31], s63 offen lds
    s_add_u32 m0, s66, 28672
    s_mov_b32 s63, 358400
    buffer_load_dwordx4 v40, s[28:31], s63 offen lds
    s_add_u32 m0, s66, 32768
    s_mov_b32 s63, 409600
    buffer_load_dwordx4 v40, s[28:31], s63 offen lds
    s_add_u32 m0, s66, 36864
    s_mov_b32 s63, 460800
    buffer_load_dwordx4 v40, s[28:31], s63 offen lds
    s_add_u32 m0, s66, 40960
    s_mov_b32 s63, 512000
    buffer_load_dwordx4 v40, s[28:31], s63 offen lds
    s_add_u32 m0, s66, 45056
    s_mov_b32 s63, 563200
    buffer_load_dwordx4 v40, s[28:31], s63 offen lds
    s_add_u32 m0, s66, 49152
    s_mov_b32 s63, 614400
    buffer_load_dwordx4 v40, s[28:31], s63 offen lds
    s_add_u32 m0, s66, 53248
    s_mov_b32 s63, 665600
    buffer_load_dwordx4 v40, s[28:31], s63 offen lds
    s_add_u32 m0, s66, 57344
    s_mov_b32 s63, 716800
    buffer_load_dwordx4 v40, s[28:31], s63 offen lds
    s_add_u32 m0, s66, 61440
    s_mov_b32 s63, 768000
    buffer_load_dwordx4 v40, s[28:31], s63 offen lds
    s_add_u32 m0, s66, 65536
    s_mov_b32 s63, 0
    buffer_load_dwordx4 v41, s[28:31], s63 offen lds
    s_add_u32 m0, s66, 69632
    s_mov_b32 s63, 204800
    buffer_load_dwordx4 v41, s[28:31], s63 offen lds
    s_add_u32 m0, s66, 73728
    s_mov_b32 s63, 409600
    buffer_load_dwordx4 v41, s[28:31], s63 offen lds
    s_add_u32 m0, s66, 77824
    s_mov_b32 s63, 614400
    buffer_load_dwordx4 v41, s[28:31], s63 offen lds
    s_waitcnt vmcnt(0)
    s_barrier
L_A2:
    v_lshrrev_b32 v15, 4, v0
    v_bfe_u32 v1, v0, 2, 2
    v_lshl_add_u32 v2, v15, 3, v1
    v_lshlrev_b32 v2, 7, v2
    v_and_b32 v3, 3, v0
    v_lshl_add_u32 v2, v3, 3, v2
    v_lshrrev_b32 v1, 1, v1
    v_and_b32 v3, 1, v15
    v_lshl_or_b32 v1, v3, 1, v1
    v_lshl_add_u32 v4, v1, 5, v2
    v_xor_b32 v5, 32, v4
    v_xor_b32 v6, 64, v4
    v_xor_b32 v7, 96, v4
    ds_read_b64_tr_b16 v[208:209], v4 offset:0
    ds_read_b64_tr_b16 v[210:211], v4 offset:512
    ds_read_b64_tr_b16 v[212:213], v5 offset:0
    ds_read_b64_tr_b16 v[214:215], v5 offset:512
    ds_read_b64_tr_b16 v[216:217], v6 offset:0
    ds_read_b64_tr_b16 v[218:219], v6 offset:512
    ds_read_b64_tr_b16 v[220:221], v7 offset:0
    ds_read_b64_tr_b16 v[222:223], v7 offset:512
    ds_read_b64_tr_b16 v[224:225], v4 offset:4096
    ds_read_b64_tr_b16 v[226:227], v4 offset:4608
    ds_read_b64_tr_b16 v[228:229], v5 offset:4096
    ds_read_b64_tr_b16 v[230:231], v5 offset:4608
    ds_read_b64_tr_b16 v[232:233], v6 offset:4096
    ds_read_b64_tr_b16 v[234:235], v6 offset:4608
    ds_read_b64_tr_b16 v[236:237], v7 offset:4096
    ds_read_b64_tr_b16 v[238:239], v7 offset:4608
    ds_read_b64_tr_b16 v[240:241], v4 offset:8192
    ds_read_b64_tr_b16 v[242:243], v4 offset:8704
    ds_read_b64_tr_b16 v[244:245], v5 offset:8192
    ds_read_b64_tr_b16 v[246:247], v5 offset:8704
    ds_read_b64_tr_b16 v[248:249], v6 offset:8192
    ds_read_b64_tr_b16 v[250:251], v6 offset:8704
    ds_read_b64_tr_b16 v[252:253], v7 offset:8192
    ds_read_b64_tr_b16 v[254:255], v7 offset:8704
    s_lshl_b32 s64, s19, 6
    s_add_u32 s64, s64, s18
    s_mul_i32 s64, s64, 20480
    v_and_b32 v14, 15, v0
    v_lshlrev_b32 v8, 4, v0
    s_lshl_b32 s65, s18, 5
    s_add_u32 s65, s65, s19
    v_lshl_add_u32 v1, v14, 1, s65
    v_mul_u32_u24 v1, 2560, v1
    v_lshlrev_b32 v2, 5, v3
    v_lshrrev_b32 v3, 1, v15
    v_lshl_add_u32 v2, v3, 4, v2
    v_add3_u32 v10, v1, v2, s58
    s_and_b32 s63, s50, 1
    s_lshl_b32 s63, s63, 7
    s_mov_b32 s63, 0
    s_cmp_lt_u32 s51, 8
    s_cbranch_scc1 L_nolate
    v_mov_b32 v20, 159792
    s_mov_b32 s69, 0
L_ls_53:
    ds_read_b128 v[16:19], v20
    s_add_u32 s69, s69, 1
    s_cmp_gt_u32 s69, 1048576
    s_cbranch_scc1 L_lsok_54
    s_waitcnt lgkmcnt(0)
    v_and_b32 v16, v16, v17
    v_and_b32 v18, v18, v19
    v_and_b32 v16, v16, v18
    v_cmp_ne_u32 vcc, 1, v16
    s_cbranch_vccz L_lsok_54
    s_branch L_ls_53
L_lsok_54:
    s_waitcnt lgkmcnt(0)
L_nolate:
    s_lshl_b32 s60, s49, 12
    s_add_u32 s60, s60, 81920
    v_lshrrev_b32 v1, 1, v15
    v_and_b32 v2, 7, v14
    v_xor_b32 v1, v1, v2
    v_lshlrev_b32 v1, 4, v1
    v_and_b32 v2, 1, v15
    v_lshl_add_u32 v1, v2, 3, v1
    v_lshl_add_u32 v1, v14, 7, v1
    v_add_u32 v11, s60, v1
    v_xor_b32 v12, 32, v11
    v_xor_b32 v13, 64, v11
    v_xor_b32 v3, 96, v11
    v_lshrrev_b32 v1, 3, v0
    v_and_b32 v14, 7, v0
    v_lshl_add_u32 v10, v1, 1, s65
    v_mul_u32_u24 v10, 2560, v10
    v_lshl_add_u32 v10, v14, 4, v10
    v_add_u32 v10, s58, v10
    v_xor_b32 v14, v14, v1
    v_lshlrev_b32 v14, 4, v14
    v_lshl_add_u32 v1, v1, 7, v14
    v_add_u32 v2, s60, v1
    s_mov_b32 s69, 0
L_poll_55:
    buffer_load_dword v1, v9, s[44:47], s63 offen offset:128 sc1
    s_add_u32 s69, s69, 1
    s_cmp_gt_u32 s69, 1048576
    s_cbranch_scc1 L_pollok_56
    s_waitcnt vmcnt(0)
    v_cmp_ne_u32 vcc, 1, v1
    s_cbranch_vccnz L_poll_55
L_pollok_56:
    s_waitcnt vmcnt(0)
    s_mov_b32 s61, s59
    s_lshl_b32 s66, s61, 12
    s_add_u32 s66, s66, s64
    s_add_u32 s67, s66, 20480
    buffer_load_dwordx4 v[16:19], v8, s[44:47], s66 offen offset:0 sc1
    buffer_load_dwordx4 v[20:23], v8, s[44:47], s67 offen offset:0 sc1
    buffer_load_dwordx4 v[24:27], v8, s[44:47], s66 offen offset:1024 sc1
    buffer_load_dwordx4 v[28:31], v8, s[44:47], s67 offen offset:1024 sc1
    buffer_load_dwordx4 v[32:35], v8, s[44:47], s66 offen offset:2048 sc1
    buffer_load_dwordx4 v[36:39], v8, s[44:47], s67 offen offset:2048 sc1
    buffer_load_dwordx4 v[40:43], v8, s[44:47], s66 offen offset:3072 sc1
    buffer_load_dwordx4 v[44:47], v8, s[44:47], s67 offen offset:3072 sc1
    s_add_u32 s66, s66, 4096
    s_add_u32 s67, s67, 4096
    buffer_load_dwordx4 v[48:51], v8, s[44:47], s66 offen offset:0 sc1
    buffer_load_dwordx4 v[52:55], v8, s[44:47], s67 offen offset:0 sc1
    buffer_load_dwordx4 v[56:59], v8, s[44:47], s66 offen offset:1024 sc1
    buffer_load_dwordx4 v[60:63], v8, s[44:47], s67 offen offset:1024 sc1
    s_waitcnt vmcnt(10)
    s_waitcnt lgkmcnt(15)
    v_mfma_f32_16x16x32_bf16 v[176:179], v[208:211], v[16:19], 0
    v_mfma_f32_16x16x32_bf16 v[180:183], v[208:211], v[20:23], 0
    buffer_load_dwordx4 v[64:67], v8, s[44:47], s66 offen offset:2048 sc1
    ds_read_b64_tr_b16 v[208:209], v4 offset:12288
    v_mfma_f32_16x16x32_bf16 v[184:187], v[212:215], v[16:19], 0
    ds_read_b64_tr_b16 v[210:211], v4 offset:12800
    v_mfma_f32_16x16x32_bf16 v[188:191], v[212:215], v[20:23], 0
    buffer_load_dwordx4 v[68:71], v8, s[44:47], s67 offen offset:2048 sc1
    ds_read_b64_tr_b16 v[212:213], v5 offset:12288
    v_mfma_f32_16x16x32_bf16 v[192:195], v[216:219], v[16:19], 0
    ds_read_b64_tr_b16 v[214:215], v5 offset:12800
    v_mfma_f32_16x16x32_bf16 v[196:199], v[216:219], v[20:23], 0
    ds_read_b64_tr_b16 v[216:217], v6 offset:12288
    v_mfma_f32_16x16x32_bf16 v[200:203], v[220:223], v[16:19], 0
    ds_read_b64_tr_b16 v[218:219], v6 offset:12800
    v_mfma_f32_16x16x32_bf16 v[204:207], v[220:223], v[20:23], 0
    ds_read_b64_tr_b16 v[220:221], v7 offset:12288
    s_waitcnt vmcnt(10)
    s_waitcnt lgkmcnt(15)
    v_mfma_f32_16x16x32_bf16 v[176:179], v[224:227], v[24:27], v[176:179]
    ds_read_b64_tr_b16 v[222:223], v7 offset:12800
    v_mfma_f32_16x16x32_bf16 v[180:183], v[224:227], v[28:31], v[180:183]
    buffer_load_dwordx4 v[72:75], v8, s[44:47], s66 offen offset:3072 sc1
    ds_read_b64_tr_b16 v[224:225], v4 offset:16384
    v_mfma_f32_16x16x32_bf16 v[184:187], v[228:231], v[24:27], v[184:187]
    ds_read_b64_tr_b16 v[226:227], v4 offset:16896
    v_mfma_f32_16x16x32_bf16 v[188:191], v[228:231], v[28:31], v[188:191]
    buffer_load_dwordx4 v[76:79], v8, s[44:47], s67 offen offset:3072 sc1
    ds_read_b64_tr_b16 v[228:229], v5 offset:16384
    v_mfma_f32_16x16x32_bf16 v[192:195], v[232:235], v[24:27], v[192:195]
    ds_read_b64_tr_b16 v[230:231], v5 offset:16896
    v_mfma_f32_16x16x32_bf16 v[196:199], v[232:235], v[28:31], v[196:199]
    ds_read_b64_tr_b16 v[232:233], v6 offset:16384
    v_mfma_f32_16x16x32_bf16 v[200:203], v[236:239], v[24:27], v[200:203]
    ds_read_b64_tr_b16 v[234:235], v6 offset:16896
    v_mfma_f32_16x16x32_bf16 v[204:207], v[236:239], v[28:31], v[204:207]
    ds_read_b64_tr_b16 v[236:237], v7 offset:16384
    s_waitcnt vmcnt(10)
    s_waitcnt lgkmcnt(15)
    s_add_u32 s66, s66, 4096
    s_add_u32 s67, s67, 4096
    v_mfma_f32_16x16x32_bf16 v[176:179], v[240:243], v[32:35], v[176:179]
    ds_read_b64_tr_b16 v[238:239], v7 offset:16896
    v_mfma_f32_16x16x32_bf16 v[180:183], v[240:243], v[36:39], v[180:183]
    buffer_load_dwordx4 v[80:83], v8, s[44:47], s66 offen offset:0 sc1
    ds_read_b64_tr_b16 v[240:241], v4 offset:20480
    v_mfma_f32_16x16x32_bf16 v[184:187], v[244:247], v[32:35], v[184:187]
    ds_read_b64_tr_b16 v[242:243], v4 offset:20992
    v_mfma_f32_16x16x32_bf16 v[188:191], v[244:247], v[36:39], v[188:191]
    buffer_load_dwordx4 v[84:87], v8, s[44:47], s67 offen offset:0 sc1
    ds_read_b64_tr_b16 v[244:245], v5 offset:20480
    v_mfma_f32_16x16x32_bf16 v[192:195], v[248:251], v[32:35], v[192:195]
    ds_read_b64_tr_b16 v[246:247], v5 offset:20992
    v_mfma_f32_16x16x32_bf16 v[196:199], v[248:251], v[36:39], v[196:199]
    ds_read_b64_tr_b16 v[248:249], v6 offset:20480
    v_mfma_f32_16x16x32_bf16 v[200:203], v[252:255], v[32:35], v[200:203]
    ds_read_b64_tr_b16 v[250:251], v6 offset:20992
    v_mfma_f32_16x16x32_bf16 v[204:207], v[252:255], v[36:39], v[204:207]
    ds_read_b64_tr_b16 v[252:253], v7 offset:20480
    s_waitcnt vmcnt(10)
    s_waitcnt lgkmcnt(15)
    v_mfma_f32_16x16x32_bf16 v[176:179], v[208:211], v[40:43], v[176:179]
    ds_read_b64_tr_b16 v[254:255], v7 offset:20992
    v_mfma_f32_16x16x32_bf16 v[180:183], v[208:211], v[44:47], v[180:183]
    buffer_load_dwordx4 v[88:91], v8, s[44:47], s66 offen offset:1024 sc1
    ds_read_b64_tr_b16 v[208:209], v4 offset:24576
    v_mfma_f32_16x16x32_bf16 v[184:187], v[212:215], v[40:43], v[184:187]
    ds_read_b64_tr_b16 v[210:211], v4 offset:25088
    v_mfma_f32_16x16x32_bf16 v[188:191], v[212:215], v[44:47], v[188:191]
    buffer_load_dwordx4 v[92:95], v8, s[44:47], s67 offen offset:1024 sc1
    ds_read_b64_tr_b16 v[212:213], v5 offset:24576
    v_mfma_f32_16x16x32_bf16 v[192:195], v[216:219], v[40:43], v[192:195]
    ds_read_b64_tr_b16 v[214:215], v5 offset:25088
    v_mfma_f32_16x16x32_bf16 v[196:199], v[216:219], v[44:47], v[196:199]
    ds_read_b64_tr_b16 v[216:217], v6 offset:24576
    v_mfma_f32_16x16x32_bf16 v[200:203], v[220:223], v[40:43], v[200:203]
    ds_read_b64_tr_b16 v[218:219], v6 offset:25088
    v_mfma_f32_16x16x32_bf16 v[204:207], v[220:223], v[44:47], v[204:207]
    ds_read_b64_tr_b16 v[220:221], v7 offset:24576
    s_waitcnt vmcnt(10)
    s_waitcnt lgkmcnt(15)
    v_mfma_f32_16x16x32_bf16 v[176:179], v[224:227], v[48:51], v[176:179]
    ds_read_b64_tr_b16 v[222:223], v7 offset:25088
    v_mfma_f32_16x16x32_bf16 v[180:183], v[224:227], v[52:55], v[180:183]
    buffer_load_dwordx4 v[96:99], v8, s[44:47], s66 offen offset:2048 sc1
    ds_read_b64_tr_b16 v[224:225], v4 offset:28672
    v_mfma_f32_16x16x32_bf16 v[184:187], v[228:231], v[48:51], v[184:187]
    ds_read_b64_tr_b16 v[226:227], v4 offset:29184
    v_mfma_f32_16x16x32_bf16 v[188:191], v[228:231], v[52:55], v[188:191]
    buffer_load_dwordx4 v[100:103], v8, s[44:47], s67 offen offset:2048 sc1
    ds_read_b64_tr_b16 v[228:229], v5 offset:28672
    v_mfma_f32_16x16x32_bf16 v[192:195], v[232:235], v[48:51], v[192:195]
    ds_read_b64_tr_b16 v[230:231], v5 offset:29184
    v_mfma_f32_16x16x32_bf16 v[196:199], v[232:235], v[52:55], v[196:199]
    ds_read_b64_tr_b16 v[232:233], v6 offset:28672
    v_mfma_f32_16x16x32_bf16 v[200:203], v[236:239], v[48:51], v[200:203]
    ds_read_b64_tr_b16 v[234:235], v6 offset:29184
    v_mfma_f32_16x16x32_bf16 v[204:207], v[236:239], v[52:55], v[204:207]
    ds_read_b64_tr_b16 v[236:237], v7 offset:28672
    s_waitcnt vmcnt(10)
    s_waitcnt lgkmcnt(15)
    v_mfma_f32_16x16x32_bf16 v[176:179], v[240:243], v[56:59], v[176:179]
    ds_read_b64_tr_b16 v[238:239], v7 offset:29184
    v_mfma_f32_16x16x32_bf16 v[180:183], v[240:243], v[60:63], v[180:183]
    buffer_load_dwordx4 v[104:107], v8, s[44:47], s66 offen offset:3072 sc1
    ds_read_b64_tr_b16 v[240:241], v4 offset:32768
    v_mfma_f32_16x16x32_bf16 v[184:187], v[244:247], v[56:59], v[184:187]
    ds_read_b64_tr_b16 v[242:243], v4 offset:33280
    v_mfma_f32_16x16x32_bf16 v[188:191], v[244:247], v[60:63], v[188:191]
    buffer_load_dwordx4 v[108:111], v8, s[44:47], s67 offen offset:3072 sc1
    ds_read_b64_tr_b16 v[244:245], v5 offset:32768
    v_mfma_f32_16x16x32_bf16 v[192:195], v[248:251], v[56:59], v[192:195]
    ds_read_b64_tr_b16 v[246:247], v5 offset:33280
    v_mfma_f32_16x16x32_bf16 v[196:199], v[248:251], v[60:63], v[196:199]
    ds_read_b64_tr_b16 v[248:249], v6 offset:32768
    v_mfma_f32_16x16x32_bf16 v[200:203], v[252:255], v[56:59], v[200:203]
    ds_read_b64_tr_b16 v[250:251], v6 offset:33280
    v_mfma_f32_16x16x32_bf16 v[204:207], v[252:255], v[60:63], v[204:207]
    ds_read_b64_tr_b16 v[252:253], v7 offset:32768
    s_waitcnt vmcnt(10)
    s_waitcnt lgkmcnt(15)
    s_add_u32 s66, s66, 4096
    s_add_u32 s67, s67, 4096
    v_mfma_f32_16x16x32_bf16 v[176:179], v[208:211], v[64:67], v[176:179]
    ds_read_b64_tr_b16 v[254:255], v7 offset:33280
    v_mfma_f32_16x16x32_bf16 v[180:183], v[208:211], v[68:71], v[180:183]
    buffer_load_dwordx4 v[112:115], v8, s[44:47], s66 offen offset:0 sc1
    ds_read_b64_tr_b16 v[208:209], v4 offset:36864
    v_mfma_f32_16x16x32_bf16 v[184:187], v[212:215], v[64:67], v[184:187]
    ds_read_b64_tr_b16 v[210:211], v4 offset:37376
    v_mfma_f32_16x16x32_bf16 v[188:191], v[212:215], v[68:71], v[188:191]
    buffer_load_dwordx4 v[116:119], v8, s[44:47], s67 offen offset:0 sc1
    ds_read_b64_tr_b16 v[212:213], v5 offset:36864
    v_mfma_f32_16x16x32_bf16 v[192:195], v[216:219], v[64:67], v[192:195]
    ds_read_b64_tr_b16 v[214:215], v5 offset:37376
    v_mfma_f32_16x16x32_bf16 v[196:199], v[216:219], v[68:71], v[196:199]
    ds_read_b64_tr_b16 v[216:217], v6 offset:36864
    v_mfma_f32_16x16x32_bf16 v[200:203], v[220:223], v[64:67], v[200:203]
    ds_read_b64_tr_b16 v[218:219], v6 offset:37376
    v_mfma_f32_16x16x32_bf16 v[204:207], v[220:223], v[68:71], v[204:207]
    ds_read_b64_tr_b16 v[220:221], v7 offset:36864
    s_waitcnt vmcnt(10)
    s_waitcnt lgkmcnt(15)
    v_mfma_f32_16x16x32_bf16 v[176:179], v[224:227], v[72:75], v[176:179]
    ds_read_b64_tr_b16 v[222:223], v7 offset:37376
    v_mfma_f32_16x16x32_bf16 v[180:183], v[224:227], v[76:79], v[180:183]
    buffer_load_dwordx4 v[120:123], v8, s[44:47], s66 offen offset:1024 sc1
    ds_read_b64_tr_b16 v[224:225], v4 offset:40960
    v_mfma_f32_16x16x32_bf16 v[184:187], v[228:231], v[72:75], v[184:187]
    ds_read_b64_tr_b16 v[226:227], v4 offset:41472
    v_mfma_f32_16x16x32_bf16 v[188:191], v[228:231], v[76:79], v[188:191]
    buffer_load_dwordx4 v[124:127], v8, s[44:47], s67 offen offset:1024 sc1
    ds_read_b64_tr_b16 v[228:229], v5 offset:40960
    v_mfma_f32_16x16x32_bf16 v[192:195], v[232:235], v[72:75], v[192:195]
    ds_read_b64_tr_b16 v[230:231], v5 offset:41472
    v_mfma_f32_16x16x32_bf16 v[196:199], v[232:235], v[76:79], v[196:199]
    ds_read_b64_tr_b16 v[232:233], v6 offset:40960
    v_mfma_f32_16x16x32_bf16 v[200:203], v[236:239], v[72:75], v[200:203]
    ds_read_b64_tr_b16 v[234:235], v6 offset:41472
    v_mfma_f32_16x16x32_bf16 v[204:207], v[236:239], v[76:79], v[204:207]
    ds_read_b64_tr_b16 v[236:237], v7 offset:40960
    s_waitcnt vmcnt(10)
    s_waitcnt lgkmcnt(15)
    v_mfma_f32_16x16x32_bf16 v[176:179], v[240:243], v[80:83], v[176:179]
    ds_read_b64_tr_b16 v[238:239], v7 offset:41472
    v_mfma_f32_16x16x32_bf16 v[180:183], v[240:243], v[84:87], v[180:183]
    buffer_load_dwordx4 v[128:131], v8, s[44:47], s66 offen offset:2048 sc1
    ds_read_b64_tr_b16 v[240:241], v4 offset:45056
    v_mfma_f32_16x16x32_bf16 v[184:187], v[244:247], v[80:83], v[184:187]
    ds_read_b64_tr_b16 v[242:243], v4 offset:45568
    v_mfma_f32_16x16x32_bf16 v[188:191], v[244:247], v[84:87], v[188:191]
    buffer_load_dwordx4 v[132:135], v8, s[44:47], s67 offen offset:2048 sc1
    ds_read_b64_tr_b16 v[244:245], v5 offset:45056
    v_mfma_f32_16x16x32_bf16 v[192:195], v[248:251], v[80:83], v[192:195]
    ds_read_b64_tr_b16 v[246:247], v5 offset:45568
    v_mfma_f32_16x16x32_bf16 v[196:199], v[248:251], v[84:87], v[196:199]
    ds_read_b64_tr_b16 v[248:249], v6 offset:45056
    v_mfma_f32_16x16x32_bf16 v[200:203], v[252:255], v[80:83], v[200:203]
    ds_read_b64_tr_b16 v[250:251], v6 offset:45568
    v_mfma_f32_16x16x32_bf16 v[204:207], v[252:255], v[84:87], v[204:207]
    ds_read_b64_tr_b16 v[252:253], v7 offset:45056
    s_waitcnt vmcnt(10)
    s_waitcnt lgkmcnt(15)
    v_mfma_f32_16x16x32_bf16 v[176:179], v[208:211], v[88:91], v[176:179]
    ds_read_b64_tr_b16 v[254:255], v7 offset:45568
    v_mfma_f32_16x16x32_bf16 v[180:183], v[208:211], v[92:95], v[180:183]
    buffer_load_dwordx4 v[136:139], v8, s[44:47], s66 offen offset:3072 sc1
    ds_read_b64_tr_b16 v[208:209], v4 offset:49152
    v_mfma_f32_16x16x32_bf16 v[184:187], v[212:215], v[88:91], v[184:187]
    ds_read_b64_tr_b16 v[210:211], v4 offset:49664
    v_mfma_f32_16x16x32_bf16 v[188:191], v[212:215], v[92:95], v[188:191]
    buffer_load_dwordx4 v[140:143], v8, s[44:47], s67 offen offset:3072 sc1
    ds_read_b64_tr_b16 v[212:213], v5 offset:49152
    v_mfma_f32_16x16x32_bf16 v[192:195], v[216:219], v[88:91], v[192:195]
    ds_read_b64_tr_b16 v[214:215], v5 offset:49664
    v_mfma_f32_16x16x32_bf16 v[196:199], v[216:219], v[92:95], v[196:199]
    ds_read_b64_tr_b16 v[216:217], v6 offset:49152
    v_mfma_f32_16x16x32_bf16 v[200:203], v[220:223], v[88:91], v[200:203]
    ds_read_b64_tr_b16 v[218:219], v6 offset:49664
    v_mfma_f32_16x16x32_bf16 v[204:207], v[220:223], v[92:95], v[204:207]
    ds_read_b64_tr_b16 v[220:221], v7 offset:49152
    s_waitcnt vmcnt(10)
    s_waitcnt lgkmcnt(15)
    s_add_u32 s66, s66, 4096
    s_add_u32 s67, s67, 4096
    v_mfma_f32_16x16x32_bf16 v[176:179], v[224:227], v[96:99], v[176:179]
    ds_read_b64_tr_b16 v[222:223], v7 offset:49664
    v_mfma_f32_16x16x32_bf16 v[180:183], v[224:227], v[100:103], v[180:183]
    buffer_load_dwordx4 v[144:147], v8, s[44:47], s66 offen offset:0 sc1
    ds_read_b64_tr_b16 v[224:225], v4 offset:53248
    v_mfma_f32_16x16x32_bf16 v[184:187], v[228:231], v[96:99], v[184:187]
    ds_read_b64_tr_b16 v[226:227], v4 offset:53760
    v_mfma_f32_16x16x32_bf16 v[188:191], v[228:231], v[100:103], v[188:191]
    buffer_load_dwordx4 v[148:151], v8, s[44:47], s67 offen offset:0 sc1
    ds_read_b64_tr_b16 v[228:229], v5 offset:53248
    v_mfma_f32_16x16x32_bf16 v[192:195], v[232:235], v[96:99], v[192:195]
    ds_read_b64_tr_b16 v[230:231], v5 offset:53760
    v_mfma_f32_16x16x32_bf16 v[196:199], v[232:235], v[100:103], v[196:199]
    ds_read_b64_tr_b16 v[232:233], v6 offset:53248
    v_mfma_f32_16x16x32_bf16 v[200:203], v[236:239], v[96:99], v[200:203]
    ds_read_b64_tr_b16 v[234:235], v6 offset:53760
    v_mfma_f32_16x16x32_bf16 v[204:207], v[236:239], v[100:103], v[204:207]
    ds_read_b64_tr_b16 v[236:237], v7 offset:53248
    s_waitcnt vmcnt(10)
    s_waitcnt lgkmcnt(15)
    v_mfma_f32_16x16x32_bf16 v[176:179], v[240:243], v[104:107], v[176:179]
    ds_read_b64_tr_b16 v[238:239], v7 offset:53760
    v_mfma_f32_16x16x32_bf16 v[180:183], v[240:243], v[108:111], v[180:183]
    buffer_load_dwordx4 v[152:155], v8, s[44:47], s66 offen offset:1024 sc1
    ds_read_b64_tr_b16 v[240:241], v4 offset:57344
    v_mfma_f32_16x16x32_bf16 v[184:187], v[244:247], v[104:107], v[184:187]
    ds_read_b64_tr_b16 v[242:243], v4 offset:57856
    v_mfma_f32_16x16x32_bf16 v[188:191], v[244:247], v[108:111], v[188:191]
    buffer_load_dwordx4 v[156:159], v8, s[44:47], s67 offen offset:1024 sc1
    ds_read_b64_tr_b16 v[244:245], v5 offset:57344
    v_mfma_f32_16x16x32_bf16 v[192:195], v[248:251], v[104:107], v[192:195]
    ds_read_b64_tr_b16 v[246:247], v5 offset:57856
    v_mfma_f32_16x16x32_bf16 v[196:199], v[248:251], v[108:111], v[196:199]
    ds_read_b64_tr_b16 v[248:249], v6 offset:57344
    v_mfma_f32_16x16x32_bf16 v[200:203], v[252:255], v[104:107], v[200:203]
    ds_read_b64_tr_b16 v[250:251], v6 offset:57856
    v_mfma_f32_16x16x32_bf16 v[204:207], v[252:255], v[108:111], v[204:207]
    ds_read_b64_tr_b16 v[252:253], v7 offset:57344
    s_waitcnt vmcnt(10)
    s_waitcnt lgkmcnt(15)
    v_mfma_f32_16x16x32_bf16 v[176:179], v[208:211], v[112:115], v[176:179]
    ds_read_b64_tr_b16 v[254:255], v7 offset:57856
    v_mfma_f32_16x16x32_bf16 v[180:183], v[208:211], v[116:119], v[180:183]
    buffer_load_dwordx4 v[160:163], v8, s[44:47], s66 offen offset:2048 sc1
    ds_read_b64_tr_b16 v[208:209], v4 offset:61440
    v_mfma_f32_16x16x32_bf16 v[184:187], v[212:215], v[112:115], v[184:187]
    ds_read_b64_tr_b16 v[210:211], v4 offset:61952
    v_mfma_f32_16x16x32_bf16 v[188:191], v[212:215], v[116:119], v[188:191]
    buffer_load_dwordx4 v[164:167], v8, s[44:47], s67 offen offset:2048 sc1
    ds_read_b64_tr_b16 v[212:213], v5 offset:61440
    v_mfma_f32_16x16x32_bf16 v[192:195], v[216:219], v[112:115], v[192:195]
    ds_read_b64_tr_b16 v[214:215], v5 offset:61952
    v_mfma_f32_16x16x32_bf16 v[196:199], v[216:219], v[116:119], v[196:199]
    ds_read_b64_tr_b16 v[216:217], v6 offset:61440
    v_mfma_f32_16x16x32_bf16 v[200:203], v[220:223], v[112:115], v[200:203]
    ds_read_b64_tr_b16 v[218:219], v6 offset:61952
    v_mfma_f32_16x16x32_bf16 v[204:207], v[220:223], v[116:119], v[204:207]
    ds_read_b64_tr_b16 v[220:221], v7 offset:61440
    s_waitcnt vmcnt(10)
    s_waitcnt lgkmcnt(15)
    v_mfma_f32_16x16x32_bf16 v[176:179], v[224:227], v[120:123], v[176:179]
    ds_read_b64_tr_b16 v[222:223], v7 offset:61952
    v_mfma_f32_16x16x32_bf16 v[180:183], v[224:227], v[124:127], v[180:183]
    buffer_load_dwordx4 v[168:171], v8, s[44:47], s66 offen offset:3072 sc1
    v_add_u32 v4, 0x10000, v4
    v_mfma_f32_16x16x32_bf16 v[184:187], v[228:231], v[120:123], v[184:187]
    ds_read_b64_tr_b16 v[224:225], v4 offset:0
    ds_read_b64_tr_b16 v[226:227], v4 offset:512
    v_mfma_f32_16x16x32_bf16 v[188:191], v[228:231], v[124:127], v[188:191]
    buffer_load_dwordx4 v[172:175], v8, s[44:47], s67 offen offset:3072 sc1
    v_add_u32 v5, 0x10000, v5
    v_mfma_f32_16x16x32_bf16 v[192:195], v[232:235], v[120:123], v[192:195]
    ds_read_b64_tr_b16 v[228:229], v5 offset:0
    ds_read_b64_tr_b16 v[230:231], v5 offset:512
    v_mfma_f32_16x16x32_bf16 v[196:199], v[232:235], v[124:127], v[196:199]
    v_add_u32 v6, 0x10000, v6
    v_mfma_f32_16x16x32_bf16 v[200:203], v[236:239], v[120:123], v[200:203]
    ds_read_b64_tr_b16 v[232:233], v6 offset:0
    ds_read_b64_tr_b16 v[234:235], v6 offset:512
    v_mfma_f32_16x16x32_bf16 v[204:207], v[236:239], v[124:127], v[204:207]
    v_add_u32 v7, 0x10000, v7
    s_waitcnt vmcnt(10)
    s_waitcnt lgkmcnt(15)
    v_mfma_f32_16x16x32_bf16 v[176:179], v[240:243], v[128:131], v[176:179]
    ds_read_b64_tr_b16 v[236:237], v7 offset:0
    ds_read_b64_tr_b16 v[238:239], v7 offset:512
    v_mfma_f32_16x16x32_bf16 v[180:183], v[240:243], v[132:135], v[180:183]
    ds_read_b64_tr_b16 v[240:241], v4 offset:4096
    v_mfma_f32_16x16x32_bf16 v[184:187], v[244:247], v[128:131], v[184:187]
    ds_read_b64_tr_b16 v[242:243], v4 offset:4608
    v_mfma_f32_16x16x32_bf16 v[188:191], v[244:247], v[132:135], v[188:191]
    ds_read_b64_tr_b16 v[244:245], v5 offset:4096
    v_mfma_f32_16x16x32_bf16 v[192:195], v[248:251], v[128:131], v[192:195]
    ds_read_b64_tr_b16 v[246:247], v5 offset:4608
    v_mfma_f32_16x16x32_bf16 v[196:199], v[248:251], v[132:135], v[196:199]
    ds_read_b64_tr_b16 v[248:249], v6 offset:4096
    s_waitcnt lgkmcnt(15)
    v_mfma_f32_16x16x32_bf16 v[200:203], v[252:255], v[128:131], v[200:203]
    ds_read_b64_tr_b16 v[250:251], v6 offset:4608
    v_mfma_f32_16x16x32_bf16 v[204:207], v[252:255], v[132:135], v[204:207]
    ds_read_b64_tr_b16 v[252:253], v7 offset:4096
    s_waitcnt vmcnt(8)
    v_mfma_f32_16x16x32_bf16 v[176:179], v[208:211], v[136:139], v[176:179]
    ds_read_b64_tr_b16 v[254:255], v7 offset:4608
    v_mfma_f32_16x16x32_bf16 v[180:183], v[208:211], v[140:143], v[180:183]
    ds_read_b64_tr_b16 v[208:209], v4 offset:8192
    v_mfma_f32_16x16x32_bf16 v[184:187], v[212:215], v[136:139], v[184:187]
    ds_read_b64_tr_b16 v[210:211], v4 offset:8704
    v_mfma_f32_16x16x32_bf16 v[188:191], v[212:215], v[140:143], v[188:191]
    ds_read_b64_tr_b16 v[212:213], v5 offset:8192
    v_mfma_f32_16x16x32_bf16 v[192:195], v[216:219], v[136:139], v[192:195]
    ds_read_b64_tr_b16 v[214:215], v5 offset:8704
    v_mfma_f32_16x16x32_bf16 v[196:199], v[216:219], v[140:143], v[196:199]
    ds_read_b64_tr_b16 v[216:217], v6 offset:8192
    s_waitcnt lgkmcnt(15)
    v_mfma_f32_16x16x32_bf16 v[200:203], v[220:223], v[136:139], v[200:203]
    ds_read_b64_tr_b16 v[218:219], v6 offset:8704
    v_mfma_f32_16x16x32_bf16 v[204:207], v[220:223], v[140:143], v[204:207]
    ds_read_b64_tr_b16 v[220:221], v7 offset:8192
    s_waitcnt vmcnt(6)
    v_mfma_f32_16x16x32_bf16 v[176:179], v[224:227], v[144:147], v[176:179]
    ds_read_b64_tr_b16 v[222:223], v7 offset:8704
    v_mfma_f32_16x16x32_bf16 v[180:183], v[224:227], v[148:151], v[180:183]
    ds_read_b64_tr_b16 v[224:225], v4 offset:12288
    v_mfma_f32_16x16x32_bf16 v[184:187], v[228:231], v[144:147], v[184:187]
    ds_read_b64_tr_b16 v[226:227], v4 offset:12800
    v_mfma_f32_16x16x32_bf16 v[188:191], v[228:231], v[148:151], v[188:191]
    ds_read_b64_tr_b16 v[228:229], v5 offset:12288
    v_mfma_f32_16x16x32_bf16 v[192:195], v[232:235], v[144:147], v[192:195]
    ds_read_b64_tr_b16 v[230:231], v5 offset:12800
    v_mfma_f32_16x16x32_bf16 v[196:199], v[232:235], v[148:151], v[196:199]
    ds_read_b64_tr_b16 v[232:233], v6 offset:12288
    s_waitcnt lgkmcnt(15)
    v_mfma_f32_16x16x32_bf16 v[200:203], v[236:239], v[144:147], v[200:203]
    ds_read_b64_tr_b16 v[234:235], v6 offset:12800
    v_mfma_f32_16x16x32_bf16 v[204:207], v[236:239], v[148:151], v[204:207]
    ds_read_b64_tr_b16 v[236:237], v7 offset:12288
    s_waitcnt vmcnt(4)
    v_mfma_f32_16x16x32_bf16 v[176:179], v[240:243], v[152:155], v[176:179]
    ds_read_b64_tr_b16 v[238:239], v7 offset:12800
    v_mfma_f32_16x16x32_bf16 v[180:183], v[240:243], v[156:159], v[180:183]
    v_mfma_f32_16x16x32_bf16 v[184:187], v[244:247], v[152:155], v[184:187]
    v_mfma_f32_16x16x32_bf16 v[188:191], v[244:247], v[156:159], v[188:191]
    v_mfma_f32_16x16x32_bf16 v[192:195], v[248:251], v[152:155], v[192:195]
    v_mfma_f32_16x16x32_bf16 v[196:199], v[248:251], v[156:159], v[196:199]
    s_waitcnt lgkmcnt(15)
    v_mfma_f32_16x16x32_bf16 v[200:203], v[252:255], v[152:155], v[200:203]
    v_mfma_f32_16x16x32_bf16 v[204:207], v[252:255], v[156:159], v[204:207]
    s_waitcnt vmcnt(2)
    s_waitcnt lgkmcnt(14)
    v_mfma_f32_16x16x32_bf16 v[176:179], v[208:211], v[160:163], v[176:179]
    v_mfma_f32_16x16x32_bf16 v[180:183], v[208:211], v[164:167], v[180:183]
    s_waitcnt lgkmcnt(12)
    v_mfma_f32_16x16x32_bf16 v[184:187], v[212:215], v[160:163], v[184:187]
    v_mfma_f32_16x16x32_bf16 v[188:191], v[212:215], v[164:167], v[188:191]
    s_waitcnt lgkmcnt(10)
    v_mfma_f32_16x16x32_bf16 v[192:195], v[216:219], v[160:163], v[192:195]
    v_mfma_f32_16x16x32_bf16 v[196:199], v[216:219], v[164:167], v[196:199]
    s_waitcnt lgkmcnt(8)
    v_mfma_f32_16x16x32_bf16 v[200:203], v[220:223], v[160:163], v[200:203]
    v_mfma_f32_16x16x32_bf16 v[204:207], v[220:223], v[164:167], v[204:207]
    s_waitcnt vmcnt(0)
    s_waitcnt lgkmcnt(6)
    v_mfma_f32_16x16x32_bf16 v[176:179], v[224:227], v[168:171], v[176:179]
    v_mfma_f32_16x16x32_bf16 v[180:183], v[224:227], v[172:175], v[180:183]
    s_waitcnt lgkmcnt(4)
    v_mfma_f32_16x16x32_bf16 v[184:187], v[228:231], v[168:171], v[184:187]
    v_mfma_f32_16x16x32_bf16 v[188:191], v[228:231], v[172:175], v[188:191]
    s_waitcnt lgkmcnt(2)
    v_mfma_f32_16x16x32_bf16 v[192:195], v[232:235], v[168:171], v[192:195]
    v_mfma_f32_16x16x32_bf16 v[196:199], v[232:235], v[172:175], v[196:199]
    s_waitcnt lgkmcnt(0)
    v_mfma_f32_16x16x32_bf16 v[200:203], v[236:239], v[168:171], v[200:203]
    v_mfma_f32_16x16x32_bf16 v[204:207], v[236:239], v[172:175], v[204:207]
    v_cvt_pk_bf16_f32 v16, v176, v177
    v_cvt_pk_bf16_f32 v17, v178, v179
    ds_write_b64 v11, v[16:17] offset:0
    v_cvt_pk_bf16_f32 v18, v184, v185
    v_cvt_pk_bf16_f32 v19, v186, v187
    ds_write_b64 v12, v[18:19] offset:0
    v_cvt_pk_bf16_f32 v20, v192, v193
    v_cvt_pk_bf16_f32 v21, v194, v195
    ds_write_b64 v13, v[20:21] offset:0
    v_cvt_pk_bf16_f32 v22, v200, v201
    v_cvt_pk_bf16_f32 v23, v202, v203
    ds_write_b64 v3, v[22:23] offset:0
    ds_read_b128 v[32:35], v2 offset:0
    ds_read_b128 v[36:39], v2 offset:1024
    v_cvt_pk_bf16_f32 v24, v180, v181
    v_cvt_pk_bf16_f32 v25, v182, v183
    ds_write_b64 v11, v[24:25] offset:2048
    v_cvt_pk_bf16_f32 v26, v188, v189
    v_cvt_pk_bf16_f32 v27, v190, v191
    ds_write_b64 v12, v[26:27] offset:2048
    v_cvt_pk_bf16_f32 v28, v196, v197
    v_cvt_pk_bf16_f32 v29, v198, v199
    ds_write_b64 v13, v[28:29] offset:2048
    v_cvt_pk_bf16_f32 v30, v204, v205
    v_cvt_pk_bf16_f32 v31, v206, v207
    ds_write_b64 v3, v[30:31] offset:2048
    ds_read_b128 v[40:43], v2 offset:2048
    ds_read_b128 v[44:47], v2 offset:3072
    s_mov_b32 s60, 0
    s_waitcnt lgkmcnt(7)
    buffer_store_dwordx4 v[32:35], v10, s[36:39], s60 offen sc1
    s_mov_b32 s60, 40960
    s_waitcnt lgkmcnt(6)
    buffer_store_dwordx4 v[36:39], v10, s[36:39], s60 offen sc1
    s_mov_b32 s60, 81920
    s_waitcnt lgkmcnt(1)
    buffer_store_dwordx4 v[40:43], v10, s[36:39], s60 offen sc1
    s_mov_b32 s60, 122880
    s_waitcnt lgkmcnt(0)
    buffer_store_dwordx4 v[44:47], v10, s[36:39], s60 offen sc1
    s_endpgm
L_end:
    s_endpgm

.section .rodata,"a"
.p2align 6
.amdhsa_kernel concat_heads__sliding_local_dilated__spectral_fnet__prompt_kernel
  .amdhsa_next_free_vgpr 256
  .amdhsa_next_free_sgpr 102
  .amdhsa_accum_offset 256
  .amdhsa_group_segment_fixed_size 0
  .amdhsa_kernarg_size 88
  .amdhsa_user_sgpr_count 2
  .amdhsa_user_sgpr_kernarg_segment_ptr 1
  .amdhsa_system_sgpr_workgroup_id_x 1
.end_amdhsa_kernel
```
